```python
import torch

def _softmax(x, axis=-1):
    return torch.softmax(x, dim=axis)
def _gelu(x):
    return torch.nn.functional.gelu(x, approximate="tanh")
def _silu(x):
    return torch.nn.functional.silu(x)
def _sigmoid(x):
    return torch.sigmoid(x)
def _layernorm(x, axis=-1, eps=1e-5):
    m = x.mean(dim=axis, keepdim=True)
    v = x.var(dim=axis, keepdim=True, unbiased=False)
    return (x - m) / torch.sqrt(v + eps)
def _scatter_add(tgt, idx, src, axis=0):
    return tgt.clone().index_add_(axis, idx, src)
def _segment_sum(src, seg, n):
    out = torch.zeros((n,) + src.shape[1:], dtype=src.dtype)
    return out.index_add_(0, seg, src)
def _pad(x, pw):
    flat = tuple(v for pair in reversed(pw) for v in pair)
    return torch.nn.functional.pad(x, flat)

kernel_name = 'standalone__gqa_block_cached__sampling'

def setup_inputs():

    _w = (lambda a: (lambda t: t.to(torch.bfloat16) if t.is_floating_point() else t)(torch.as_tensor(a)))
    B, Sq, D = 8, 4, 512
    Hq, Hkv, Sk, Dh = 32, 8, 2048, 128
    assert Hq % Hkv == 0, (Hq, Hkv)
    return {
        "x": _w((lambda *s: torch.randn(*s, dtype=torch.bfloat16) * 0.8)(B, Sq, D)),
        "k_cache": _w((lambda *s: torch.randn(*s, dtype=torch.bfloat16) * 0.8)(B, Hkv, Sk, Dh)),
        "v_cache": _w((lambda *s: torch.randn(*s, dtype=torch.bfloat16) * 0.05)(B, Hkv, Sk, Dh)),
        "wq": _w((lambda *s: torch.randn(*s, dtype=torch.bfloat16) * 0.8)(D, Hq * Dh) * (D ** -0.5)),
        "wo": _w((lambda *s: torch.randn(*s, dtype=torch.bfloat16) * 0.05)(Hq * Dh, D) * ((Hq * Dh) ** -0.5)),
    }

def reference(x, k_cache, v_cache, wq, wo):
    B, Sq, D = x.shape
    Hq, Dh = 32, 128
    Hkv = k_cache.shape[1]
    rep = Hq // Hkv
    q = (lambda x, *d: x.permute(*d))((x @ wq).reshape(B, Sq, Hq, Dh), 0, 2, 1, 3)
    k = (lambda x, n, axis: torch.repeat_interleave(x, n, dim=axis))(k_cache, rep, axis=1)
    v = (lambda x, n, axis: torch.repeat_interleave(x, n, dim=axis))(v_cache, rep, axis=1)
    scores = torch.einsum("bhqd,bhkd->bhqk", q, k) * (Dh ** -0.5)
    p = _softmax(scores, axis=-1)
    o = torch.einsum("bhqk,bhkd->bhqd", p, v)
    return (lambda x, *d: x.permute(*d))(o, 0, 2, 1, 3).reshape(B, Sq, Hq * Dh) @ wo
```

```asm
; @launch grid=(256,1,1) block=(768,1,1) lds=163840
.amdgcn_target "amdgcn-amd-amdhsa--gfx950"
.text
.globl standalone__gqa_block_cached__sampling_kernel
.p2align 8
.type standalone__gqa_block_cached__sampling_kernel,@function
standalone__gqa_block_cached__sampling_kernel:
    s_cmp_ge_u32 s2, 256
    s_cbranch_scc1 L_done
    s_load_dwordx16 s[64:79], s[0:1], 0
    s_memrealtime s[98:99]
    v_and_b32 v1, 63, v0
    v_lshrrev_b32 v4, 6, v0
    v_and_b32 v2, 15, v0
    v_bfe_u32 v3, v0, 4, 2
    v_readfirstlane_b32 s44, v4
    s_and_b32 s40, s2, 7
    s_lshr_b32 s41, s2, 3
    s_lshr_b32 s42, s41, 2
    s_and_b32 s43, s41, 3
    s_lshl_b32 s45, s42, 3
    s_add_u32 s45, s45, s40
    s_lshl_b32 s51, s40, 2
    s_add_u32 s51, s51, s43
    s_lshl_b32 s63, s51, 8
    s_mov_b32 s3, 16777216
    v_mov_b32 v6, 149056
    s_cmp_lt_u32 s44, 8
    s_cbranch_scc1 L_cw
    s_sub_u32 s48, s44, 8
    v_lshlrev_b32 v4, 13, v3
    v_lshl_add_u32 v4, v2, 3, v4
    s_lshl_b32 s97, s63, 9
    s_lshl_b32 s50, s48, 7
    s_add_u32 s97, s97, s50
    s_and_b32 s50, s42, 1
    s_lshl_b32 s50, s50, 9
    s_add_u32 s97, s97, s50
    s_bitcmp0_b32 s44, 0
    s_cbranch_scc1 L_op
    s_setprio 3
    s_lshr_b32 s49, s48, 1
    s_lshl_b32 s46, s45, 2
    s_add_u32 s46, s46, s43
    s_lshl_b32 s46, s46, 17
    s_lshl_b32 s47, s49, 16
    s_add_u32 s46, s46, s47
    s_lshl_b32 s50, s49, 2
    v_add_u32 v7, s50, v6
    s_add_u32 s94, s41, s40
    v_xor_b32 v8, v2, v3
    v_lshlrev_b32 v8, 4, v8
    v_lshl_add_u32 v8, v3, 8, v8
    v_lshlrev_b32 v12, 1, v3
    v_xor_b32 v12, v2, v12
    v_lshlrev_b32 v12, 4, v12
    v_lshl_add_u32 v12, v3, 8, v12
    v_xor_b32 v9, 64, v8
    v_xor_b32 v10, 0x80, v8
    v_xor_b32 v11, 0xc0, v8
    v_xor_b32 v13, 0x80, v12
    s_add_u32 s95, s42, s49
    s_add_u32 s50, s94, 0
    s_and_b32 s50, s50, 3
    s_lshl_b32 s50, s50, 12
    s_add_u32 s52, s50, s46
    s_add_u32 s50, s95, 0
    s_and_b32 s50, s50, 3
    s_lshl_b32 s56, s50, 10
    s_add_u32 s50, s94, 1
    s_and_b32 s50, s50, 3
    s_lshl_b32 s50, s50, 12
    s_add_u32 s53, s50, s46
    s_add_u32 s50, s95, 1
    s_and_b32 s50, s50, 3
    s_lshl_b32 s57, s50, 10
    s_add_u32 s50, s94, 2
    s_and_b32 s50, s50, 3
    s_lshl_b32 s50, s50, 12
    s_add_u32 s54, s50, s46
    s_add_u32 s50, s95, 2
    s_and_b32 s50, s50, 3
    s_lshl_b32 s58, s50, 10
    s_add_u32 s50, s94, 3
    s_and_b32 s50, s50, 3
    s_lshl_b32 s50, s50, 12
    s_add_u32 s55, s50, s46
    s_add_u32 s50, s95, 3
    s_and_b32 s50, s50, 3
    s_lshl_b32 s59, s50, 10
    s_waitcnt lgkmcnt(0)
    s_mov_b32 s12, s66
    s_mov_b32 s13, s67
    s_mov_b32 s14, 33554432
    s_mov_b32 s15, 0x00020000
    s_mov_b32 s16, s68
    s_mov_b32 s17, s69
    s_mov_b32 s18, 33554432
    s_mov_b32 s19, 0x00020000
    s_mov_b32 s24, s72
    s_mov_b32 s25, s73
    s_mov_b32 s26, 4194304
    s_mov_b32 s27, 0x00020000
    s_mov_b32 s36, s78
    s_mov_b32 s37, s79
    s_mov_b32 s38, 268435456
    s_mov_b32 s39, 0x00020000
    s_barrier
    s_add_u32 m0, s47, 0
    s_add_u32 s50, s52, s56
    s_add_u32 s50, s50, 0
    buffer_load_dwordx4 v8, s[12:15], s50 offen nt lds
    s_add_u32 m0, s47, 16384
    s_add_u32 s50, s53, s57
    s_add_u32 s50, s50, 16384
    buffer_load_dwordx4 v8, s[12:15], s50 offen nt lds
    s_add_u32 m0, s47, 32768
    s_add_u32 s50, s54, s58
    s_add_u32 s50, s50, 32768
    buffer_load_dwordx4 v8, s[12:15], s50 offen nt lds
    s_add_u32 m0, s47, 49152
    s_add_u32 s50, s55, s59
    s_add_u32 s50, s50, 49152
    buffer_load_dwordx4 v8, s[12:15], s50 offen nt lds
    s_add_u32 m0, s47, 1024
    s_add_u32 s50, s52, s57
    s_add_u32 s50, s50, 0
    buffer_load_dwordx4 v9, s[12:15], s50 offen nt lds
    s_add_u32 m0, s47, 17408
    s_add_u32 s50, s53, s58
    s_add_u32 s50, s50, 16384
    buffer_load_dwordx4 v9, s[12:15], s50 offen nt lds
    s_add_u32 m0, s47, 33792
    s_add_u32 s50, s54, s59
    s_add_u32 s50, s50, 32768
    buffer_load_dwordx4 v9, s[12:15], s50 offen nt lds
    s_add_u32 m0, s47, 50176
    s_add_u32 s50, s55, s56
    s_add_u32 s50, s50, 49152
    buffer_load_dwordx4 v9, s[12:15], s50 offen nt lds
    s_add_u32 m0, s47, 2048
    s_add_u32 s50, s52, s58
    s_add_u32 s50, s50, 0
    buffer_load_dwordx4 v10, s[12:15], s50 offen nt lds
    s_add_u32 m0, s47, 18432
    s_add_u32 s50, s53, s59
    s_add_u32 s50, s50, 16384
    buffer_load_dwordx4 v10, s[12:15], s50 offen nt lds
    s_add_u32 m0, s47, 34816
    s_add_u32 s50, s54, s56
    s_add_u32 s50, s50, 32768
    buffer_load_dwordx4 v10, s[12:15], s50 offen nt lds
    s_add_u32 m0, s47, 51200
    s_add_u32 s50, s55, s57
    s_add_u32 s50, s50, 49152
    buffer_load_dwordx4 v10, s[12:15], s50 offen nt lds
    s_add_u32 m0, s47, 3072
    s_add_u32 s50, s52, s59
    s_add_u32 s50, s50, 0
    buffer_load_dwordx4 v11, s[12:15], s50 offen nt lds
    s_add_u32 m0, s47, 19456
    s_add_u32 s50, s53, s56
    s_add_u32 s50, s50, 16384
    buffer_load_dwordx4 v11, s[12:15], s50 offen nt lds
    s_add_u32 m0, s47, 35840
    s_add_u32 s50, s54, s57
    s_add_u32 s50, s50, 32768
    buffer_load_dwordx4 v11, s[12:15], s50 offen nt lds
    s_add_u32 m0, s47, 52224
    s_add_u32 s50, s55, s58
    s_add_u32 s50, s50, 49152
    buffer_load_dwordx4 v11, s[12:15], s50 offen nt lds
    s_add_u32 m0, s47, 4096
    s_add_u32 s50, s53, s56
    s_add_u32 s50, s50, 0
    buffer_load_dwordx4 v8, s[12:15], s50 offen nt lds
    s_add_u32 m0, s47, 20480
    s_add_u32 s50, s54, s57
    s_add_u32 s50, s50, 16384
    buffer_load_dwordx4 v8, s[12:15], s50 offen nt lds
    s_add_u32 m0, s47, 36864
    s_add_u32 s50, s55, s58
    s_add_u32 s50, s50, 32768
    buffer_load_dwordx4 v8, s[12:15], s50 offen nt lds
    s_add_u32 s50, s97, 0
    buffer_load_dwordx2 v[56:57], v4, s[24:27], s50 offen offset:0
    s_add_u32 m0, s47, 53248
    s_add_u32 s50, s52, s59
    s_add_u32 s50, s50, 49152
    buffer_load_dwordx4 v8, s[12:15], s50 offen nt lds
    s_add_u32 m0, s47, 5120
    s_add_u32 s50, s53, s57
    s_add_u32 s50, s50, 0
    buffer_load_dwordx4 v9, s[12:15], s50 offen nt lds
    s_add_u32 m0, s47, 21504
    s_add_u32 s50, s54, s58
    s_add_u32 s50, s50, 16384
    buffer_load_dwordx4 v9, s[12:15], s50 offen nt lds
    s_add_u32 s50, s97, 0
    buffer_load_dwordx2 v[58:59], v4, s[24:27], s50 offen offset:1024
    s_add_u32 m0, s47, 37888
    s_add_u32 s50, s55, s59
    s_add_u32 s50, s50, 32768
    buffer_load_dwordx4 v9, s[12:15], s50 offen nt lds
    s_add_u32 m0, s47, 54272
    s_add_u32 s50, s52, s56
    s_add_u32 s50, s50, 49152
    buffer_load_dwordx4 v9, s[12:15], s50 offen nt lds
    s_add_u32 m0, s47, 6144
    s_add_u32 s50, s53, s58
    s_add_u32 s50, s50, 0
    buffer_load_dwordx4 v10, s[12:15], s50 offen nt lds
    s_add_u32 s50, s97, 0
    buffer_load_dwordx2 v[60:61], v4, s[24:27], s50 offen offset:2048
    s_add_u32 m0, s47, 22528
    s_add_u32 s50, s54, s59
    s_add_u32 s50, s50, 16384
    buffer_load_dwordx4 v10, s[12:15], s50 offen nt lds
    s_add_u32 m0, s47, 38912
    s_add_u32 s50, s55, s56
    s_add_u32 s50, s50, 32768
    buffer_load_dwordx4 v10, s[12:15], s50 offen nt lds
    s_add_u32 m0, s47, 55296
    s_add_u32 s50, s52, s57
    s_add_u32 s50, s50, 49152
    buffer_load_dwordx4 v10, s[12:15], s50 offen nt lds
    s_add_u32 s50, s97, 0
    buffer_load_dwordx2 v[62:63], v4, s[24:27], s50 offen offset:3072
    s_add_u32 m0, s47, 7168
    s_add_u32 s50, s53, s59
    s_add_u32 s50, s50, 0
    buffer_load_dwordx4 v11, s[12:15], s50 offen nt lds
    s_add_u32 m0, s47, 23552
    s_add_u32 s50, s54, s56
    s_add_u32 s50, s50, 16384
    buffer_load_dwordx4 v11, s[12:15], s50 offen nt lds
    s_add_u32 m0, s47, 39936
    s_add_u32 s50, s55, s57
    s_add_u32 s50, s50, 32768
    buffer_load_dwordx4 v11, s[12:15], s50 offen nt lds
    s_add_u32 s50, s97, 4096
    buffer_load_dwordx2 v[64:65], v4, s[24:27], s50 offen offset:0
    s_add_u32 m0, s47, 56320
    s_add_u32 s50, s52, s58
    s_add_u32 s50, s50, 49152
    buffer_load_dwordx4 v11, s[12:15], s50 offen nt lds
    s_waitcnt vmcnt(24)
    s_add_u32 m0, s47, 8192
    s_add_u32 s50, s54, s56
    s_add_u32 s50, s50, 0
    buffer_load_dwordx4 v8, s[12:15], s50 offen nt lds
    s_waitcnt vmcnt(24)
    s_add_u32 m0, s47, 24576
    s_add_u32 s50, s55, s57
    s_add_u32 s50, s50, 16384
    buffer_load_dwordx4 v8, s[12:15], s50 offen nt lds
    s_add_u32 s50, s97, 4096
    buffer_load_dwordx2 v[66:67], v4, s[24:27], s50 offen offset:1024
    s_waitcnt vmcnt(25)
    s_add_u32 m0, s47, 40960
    s_add_u32 s50, s52, s58
    s_add_u32 s50, s50, 32768
    buffer_load_dwordx4 v8, s[12:15], s50 offen nt lds
    s_waitcnt vmcnt(25)
    s_add_u32 m0, s47, 57344
    s_add_u32 s50, s53, s59
    s_add_u32 s50, s50, 49152
    buffer_load_dwordx4 v8, s[12:15], s50 offen nt lds
    v_mov_b32 v14, 1
    ds_write_b32 v7, v14 offset:0
    s_waitcnt vmcnt(25)
    s_add_u32 m0, s47, 9216
    s_add_u32 s50, s54, s57
    s_add_u32 s50, s50, 0
    buffer_load_dwordx4 v9, s[12:15], s50 offen nt lds
    s_add_u32 s50, s97, 4096
    buffer_load_dwordx2 v[68:69], v4, s[24:27], s50 offen offset:2048
    s_waitcnt vmcnt(26)
    s_add_u32 m0, s47, 25600
    s_add_u32 s50, s55, s58
    s_add_u32 s50, s50, 16384
    buffer_load_dwordx4 v9, s[12:15], s50 offen nt lds
    s_waitcnt vmcnt(26)
    s_add_u32 m0, s47, 41984
    s_add_u32 s50, s52, s59
    s_add_u32 s50, s50, 32768
    buffer_load_dwordx4 v9, s[12:15], s50 offen nt lds
    s_waitcnt vmcnt(25)
    s_add_u32 m0, s47, 58368
    s_add_u32 s50, s53, s56
    s_add_u32 s50, s50, 49152
    buffer_load_dwordx4 v9, s[12:15], s50 offen nt lds
    s_add_u32 s50, s97, 4096
    buffer_load_dwordx2 v[70:71], v4, s[24:27], s50 offen offset:3072
    s_waitcnt vmcnt(26)
    s_add_u32 m0, s47, 10240
    s_add_u32 s50, s54, s58
    s_add_u32 s50, s50, 0
    buffer_load_dwordx4 v10, s[12:15], s50 offen nt lds
    s_waitcnt vmcnt(26)
    s_add_u32 m0, s47, 26624
    s_add_u32 s50, s55, s59
    s_add_u32 s50, s50, 16384
    buffer_load_dwordx4 v10, s[12:15], s50 offen nt lds
    s_waitcnt vmcnt(25)
    s_add_u32 m0, s47, 43008
    s_add_u32 s50, s52, s56
    s_add_u32 s50, s50, 32768
    buffer_load_dwordx4 v10, s[12:15], s50 offen nt lds
    s_add_u32 s50, s97, 32768
    buffer_load_dwordx2 v[72:73], v4, s[24:27], s50 offen offset:0
    s_waitcnt vmcnt(26)
    s_add_u32 m0, s47, 59392
    s_add_u32 s50, s53, s57
    s_add_u32 s50, s50, 49152
    buffer_load_dwordx4 v10, s[12:15], s50 offen nt lds
    s_waitcnt vmcnt(26)
    s_add_u32 m0, s47, 11264
    s_add_u32 s50, s54, s59
    s_add_u32 s50, s50, 0
    buffer_load_dwordx4 v11, s[12:15], s50 offen nt lds
    s_waitcnt vmcnt(25)
    s_add_u32 m0, s47, 27648
    s_add_u32 s50, s55, s56
    s_add_u32 s50, s50, 16384
    buffer_load_dwordx4 v11, s[12:15], s50 offen nt lds
    s_add_u32 s50, s97, 32768
    buffer_load_dwordx2 v[74:75], v4, s[24:27], s50 offen offset:1024
    s_waitcnt vmcnt(26)
    s_add_u32 m0, s47, 44032
    s_add_u32 s50, s52, s57
    s_add_u32 s50, s50, 32768
    buffer_load_dwordx4 v11, s[12:15], s50 offen nt lds
    s_waitcnt vmcnt(26)
    s_add_u32 m0, s47, 60416
    s_add_u32 s50, s53, s58
    s_add_u32 s50, s50, 49152
    buffer_load_dwordx4 v11, s[12:15], s50 offen nt lds
    s_mov_b32 s61, 0
Lsp_1:
    ds_read_b32 v15, v6 offset:12
    s_waitcnt lgkmcnt(0)
    v_readfirstlane_b32 s60, v15
    s_nop 3
    s_cmp_ge_u32 s60, 1
    s_cbranch_scc1 Lspd_2
    s_sleep 1
    s_add_u32 s61, s61, 1
    s_cmp_lt_u32 s61, 400000
    s_cbranch_scc1 Lsp_1
Lspd_2:
    s_waitcnt vmcnt(23)
    s_add_u32 m0, s47, 12288
    s_add_u32 s50, s55, s56
    s_add_u32 s50, s50, 0
    buffer_load_dwordx4 v8, s[12:15], s50 offen nt lds
    s_add_u32 s50, s97, 32768
    buffer_load_dwordx2 v[76:77], v4, s[24:27], s50 offen offset:2048
    s_waitcnt vmcnt(23)
    s_add_u32 m0, s47, 28672
    s_add_u32 s50, s52, s57
    s_add_u32 s50, s50, 16384
    buffer_load_dwordx4 v8, s[12:15], s50 offen nt lds
    v_mov_b32 v14, 2
    ds_write_b32 v7, v14 offset:0
    s_waitcnt vmcnt(23)
    s_add_u32 m0, s47, 45056
    s_add_u32 s50, s53, s58
    s_add_u32 s50, s50, 32768
    buffer_load_dwordx4 v8, s[12:15], s50 offen nt lds
    s_waitcnt vmcnt(23)
    s_add_u32 m0, s47, 61440
    s_add_u32 s50, s54, s59
    s_add_u32 s50, s50, 49152
    buffer_load_dwordx4 v8, s[12:15], s50 offen nt lds
    s_add_u32 s50, s97, 32768
    buffer_load_dwordx2 v[78:79], v4, s[24:27], s50 offen offset:3072
    s_waitcnt vmcnt(23)
    s_add_u32 m0, s47, 13312
    s_add_u32 s50, s55, s57
    s_add_u32 s50, s50, 0
    buffer_load_dwordx4 v9, s[12:15], s50 offen nt lds
    s_waitcnt vmcnt(23)
    s_add_u32 m0, s47, 29696
    s_add_u32 s50, s52, s58
    s_add_u32 s50, s50, 16384
    buffer_load_dwordx4 v9, s[12:15], s50 offen nt lds
    s_waitcnt vmcnt(23)
    s_add_u32 m0, s47, 46080
    s_add_u32 s50, s53, s59
    s_add_u32 s50, s50, 32768
    buffer_load_dwordx4 v9, s[12:15], s50 offen nt lds
    s_add_u32 s50, s97, 36864
    buffer_load_dwordx2 v[80:81], v4, s[24:27], s50 offen offset:0
    s_waitcnt vmcnt(23)
    s_add_u32 m0, s47, 62464
    s_add_u32 s50, s54, s56
    s_add_u32 s50, s50, 49152
    buffer_load_dwordx4 v9, s[12:15], s50 offen nt lds
    s_waitcnt vmcnt(23)
    s_add_u32 m0, s47, 14336
    s_add_u32 s50, s55, s58
    s_add_u32 s50, s50, 0
    buffer_load_dwordx4 v10, s[12:15], s50 offen nt lds
    s_waitcnt vmcnt(23)
    s_add_u32 m0, s47, 30720
    s_add_u32 s50, s52, s59
    s_add_u32 s50, s50, 16384
    buffer_load_dwordx4 v10, s[12:15], s50 offen nt lds
    s_add_u32 s50, s97, 36864
    buffer_load_dwordx2 v[82:83], v4, s[24:27], s50 offen offset:1024
    s_waitcnt vmcnt(23)
    s_add_u32 m0, s47, 47104
    s_add_u32 s50, s53, s56
    s_add_u32 s50, s50, 32768
    buffer_load_dwordx4 v10, s[12:15], s50 offen nt lds
    s_waitcnt vmcnt(23)
    s_add_u32 m0, s47, 63488
    s_add_u32 s50, s54, s57
    s_add_u32 s50, s50, 49152
    buffer_load_dwordx4 v10, s[12:15], s50 offen nt lds
    s_waitcnt vmcnt(23)
    s_add_u32 m0, s47, 15360
    s_add_u32 s50, s55, s59
    s_add_u32 s50, s50, 0
    buffer_load_dwordx4 v11, s[12:15], s50 offen nt lds
    s_add_u32 s50, s97, 36864
    buffer_load_dwordx2 v[84:85], v4, s[24:27], s50 offen offset:2048
    s_waitcnt vmcnt(23)
    s_add_u32 m0, s47, 31744
    s_add_u32 s50, s52, s56
    s_add_u32 s50, s50, 16384
    buffer_load_dwordx4 v11, s[12:15], s50 offen nt lds
    s_waitcnt vmcnt(23)
    s_add_u32 m0, s47, 48128
    s_add_u32 s50, s53, s57
    s_add_u32 s50, s50, 32768
    buffer_load_dwordx4 v11, s[12:15], s50 offen nt lds
    s_waitcnt vmcnt(23)
    s_add_u32 m0, s47, 64512
    s_add_u32 s50, s54, s58
    s_add_u32 s50, s50, 49152
    buffer_load_dwordx4 v11, s[12:15], s50 offen nt lds
    s_add_u32 s50, s97, 36864
    buffer_load_dwordx2 v[86:87], v4, s[24:27], s50 offen offset:3072
    s_mov_b32 s61, 0
Lsp_3:
    ds_read_b32 v15, v6 offset:40
    s_waitcnt lgkmcnt(0)
    v_readfirstlane_b32 s60, v15
    s_nop 3
    s_cmp_ge_u32 s60, 8
    s_cbranch_scc1 Lspd_4
    s_sleep 1
    s_add_u32 s61, s61, 1
    s_cmp_lt_u32 s61, 400000
    s_cbranch_scc1 Lsp_3
Lspd_4:
    s_waitcnt vmcnt(21)
    s_add_u32 m0, s47, 0
    s_add_u32 s50, s52, s56
    s_add_u32 s50, s50, 0
    buffer_load_dwordx4 v12, s[16:19], s50 offen nt lds
    v_mov_b32 v14, 3
    ds_write_b32 v7, v14 offset:0
    s_waitcnt vmcnt(20)
    s_add_u32 m0, s47, 16384
    s_add_u32 s50, s53, s57
    s_add_u32 s50, s50, 16384
    buffer_load_dwordx4 v12, s[16:19], s50 offen nt lds
    s_waitcnt vmcnt(20)
    s_add_u32 m0, s47, 32768
    s_add_u32 s50, s54, s58
    s_add_u32 s50, s50, 32768
    buffer_load_dwordx4 v12, s[16:19], s50 offen nt lds
    s_add_u32 s50, s97, 65536
    buffer_load_dwordx2 v[88:89], v4, s[24:27], s50 offen offset:0
    s_waitcnt vmcnt(21)
    s_add_u32 m0, s47, 49152
    s_add_u32 s50, s55, s59
    s_add_u32 s50, s50, 49152
    buffer_load_dwordx4 v12, s[16:19], s50 offen nt lds
    s_waitcnt vmcnt(20)
    s_add_u32 m0, s47, 1024
    s_add_u32 s50, s52, s57
    s_add_u32 s50, s50, 0
    buffer_load_dwordx4 v13, s[16:19], s50 offen nt lds
    s_waitcnt vmcnt(20)
    s_add_u32 m0, s47, 17408
    s_add_u32 s50, s53, s58
    s_add_u32 s50, s50, 16384
    buffer_load_dwordx4 v13, s[16:19], s50 offen nt lds
    s_add_u32 s50, s97, 65536
    buffer_load_dwordx2 v[90:91], v4, s[24:27], s50 offen offset:1024
    s_waitcnt vmcnt(21)
    s_add_u32 m0, s47, 33792
    s_add_u32 s50, s54, s59
    s_add_u32 s50, s50, 32768
    buffer_load_dwordx4 v13, s[16:19], s50 offen nt lds
    s_waitcnt vmcnt(20)
    s_add_u32 m0, s47, 50176
    s_add_u32 s50, s55, s56
    s_add_u32 s50, s50, 49152
    buffer_load_dwordx4 v13, s[16:19], s50 offen nt lds
    s_waitcnt vmcnt(20)
    s_add_u32 m0, s47, 2048
    s_add_u32 s50, s52, s58
    s_add_u32 s50, s50, 0
    buffer_load_dwordx4 v12, s[16:19], s50 offen nt lds
    s_add_u32 s50, s97, 65536
    buffer_load_dwordx2 v[92:93], v4, s[24:27], s50 offen offset:2048
    s_waitcnt vmcnt(21)
    s_add_u32 m0, s47, 18432
    s_add_u32 s50, s53, s59
    s_add_u32 s50, s50, 16384
    buffer_load_dwordx4 v12, s[16:19], s50 offen nt lds
    s_waitcnt vmcnt(20)
    s_add_u32 m0, s47, 34816
    s_add_u32 s50, s54, s56
    s_add_u32 s50, s50, 32768
    buffer_load_dwordx4 v12, s[16:19], s50 offen nt lds
    s_waitcnt vmcnt(20)
    s_add_u32 m0, s47, 51200
    s_add_u32 s50, s55, s57
    s_add_u32 s50, s50, 49152
    buffer_load_dwordx4 v12, s[16:19], s50 offen nt lds
    s_add_u32 s50, s97, 65536
    buffer_load_dwordx2 v[94:95], v4, s[24:27], s50 offen offset:3072
    s_waitcnt vmcnt(21)
    s_add_u32 m0, s47, 3072
    s_add_u32 s50, s52, s59
    s_add_u32 s50, s50, 0
    buffer_load_dwordx4 v13, s[16:19], s50 offen nt lds
    s_waitcnt vmcnt(20)
    s_add_u32 m0, s47, 19456
    s_add_u32 s50, s53, s56
    s_add_u32 s50, s50, 16384
    buffer_load_dwordx4 v13, s[16:19], s50 offen nt lds
    s_waitcnt vmcnt(20)
    s_add_u32 m0, s47, 35840
    s_add_u32 s50, s54, s57
    s_add_u32 s50, s50, 32768
    buffer_load_dwordx4 v13, s[16:19], s50 offen nt lds
    s_add_u32 s50, s97, 69632
    buffer_load_dwordx2 v[96:97], v4, s[24:27], s50 offen offset:0
    s_waitcnt vmcnt(21)
    s_add_u32 m0, s47, 52224
    s_add_u32 s50, s55, s58
    s_add_u32 s50, s50, 49152
    buffer_load_dwordx4 v13, s[16:19], s50 offen nt lds
    v_mov_b32 v14, 4
    ds_write_b32 v7, v14 offset:0
    s_mov_b32 s61, 0
Lsp_5:
    ds_read_b32 v15, v6 offset:44
    s_waitcnt lgkmcnt(0)
    v_readfirstlane_b32 s60, v15
    s_nop 3
    s_cmp_ge_u32 s60, 8
    s_cbranch_scc1 Lspd_6
    s_sleep 1
    s_add_u32 s61, s61, 1
    s_cmp_lt_u32 s61, 400000
    s_cbranch_scc1 Lsp_5
Lspd_6:
    s_waitcnt vmcnt(18)
    s_add_u32 m0, s47, 4096
    s_add_u32 s50, s53, s56
    s_add_u32 s50, s50, 0
    buffer_load_dwordx4 v12, s[16:19], s50 offen nt lds
    s_waitcnt vmcnt(17)
    s_add_u32 m0, s47, 20480
    s_add_u32 s50, s54, s57
    s_add_u32 s50, s50, 16384
    buffer_load_dwordx4 v12, s[16:19], s50 offen nt lds
    s_add_u32 s50, s97, 69632
    buffer_load_dwordx2 v[98:99], v4, s[24:27], s50 offen offset:1024
    s_waitcnt vmcnt(18)
    s_add_u32 m0, s47, 36864
    s_add_u32 s50, s55, s58
    s_add_u32 s50, s50, 32768
    buffer_load_dwordx4 v12, s[16:19], s50 offen nt lds
    s_waitcnt vmcnt(18)
    s_add_u32 m0, s47, 53248
    s_add_u32 s50, s52, s59
    s_add_u32 s50, s50, 49152
    buffer_load_dwordx4 v12, s[16:19], s50 offen nt lds
    s_waitcnt vmcnt(17)
    s_add_u32 m0, s47, 5120
    s_add_u32 s50, s53, s57
    s_add_u32 s50, s50, 0
    buffer_load_dwordx4 v13, s[16:19], s50 offen nt lds
    s_add_u32 s50, s97, 69632
    buffer_load_dwordx2 v[100:101], v4, s[24:27], s50 offen offset:2048
    s_waitcnt vmcnt(18)
    s_add_u32 m0, s47, 21504
    s_add_u32 s50, s54, s58
    s_add_u32 s50, s50, 16384
    buffer_load_dwordx4 v13, s[16:19], s50 offen nt lds
    s_waitcnt vmcnt(18)
    s_add_u32 m0, s47, 37888
    s_add_u32 s50, s55, s59
    s_add_u32 s50, s50, 32768
    buffer_load_dwordx4 v13, s[16:19], s50 offen nt lds
    s_waitcnt vmcnt(17)
    s_add_u32 m0, s47, 54272
    s_add_u32 s50, s52, s56
    s_add_u32 s50, s50, 49152
    buffer_load_dwordx4 v13, s[16:19], s50 offen nt lds
    s_add_u32 s50, s97, 69632
    buffer_load_dwordx2 v[102:103], v4, s[24:27], s50 offen offset:3072
    s_waitcnt vmcnt(18)
    s_add_u32 m0, s47, 6144
    s_add_u32 s50, s53, s58
    s_add_u32 s50, s50, 0
    buffer_load_dwordx4 v12, s[16:19], s50 offen nt lds
    s_waitcnt vmcnt(18)
    s_add_u32 m0, s47, 22528
    s_add_u32 s50, s54, s59
    s_add_u32 s50, s50, 16384
    buffer_load_dwordx4 v12, s[16:19], s50 offen nt lds
    s_waitcnt vmcnt(17)
    s_add_u32 m0, s47, 38912
    s_add_u32 s50, s55, s56
    s_add_u32 s50, s50, 32768
    buffer_load_dwordx4 v12, s[16:19], s50 offen nt lds
    s_add_u32 s50, s97, 98304
    buffer_load_dwordx2 v[104:105], v4, s[24:27], s50 offen offset:0
    s_waitcnt vmcnt(18)
    s_add_u32 m0, s47, 55296
    s_add_u32 s50, s52, s57
    s_add_u32 s50, s50, 49152
    buffer_load_dwordx4 v12, s[16:19], s50 offen nt lds
    s_waitcnt vmcnt(18)
    s_add_u32 m0, s47, 7168
    s_add_u32 s50, s53, s59
    s_add_u32 s50, s50, 0
    buffer_load_dwordx4 v13, s[16:19], s50 offen nt lds
    s_waitcnt vmcnt(17)
    s_add_u32 m0, s47, 23552
    s_add_u32 s50, s54, s56
    s_add_u32 s50, s50, 16384
    buffer_load_dwordx4 v13, s[16:19], s50 offen nt lds
    v_mov_b32 v14, 5
    ds_write_b32 v7, v14 offset:0
    s_add_u32 s50, s97, 98304
    buffer_load_dwordx2 v[106:107], v4, s[24:27], s50 offen offset:1024
    s_waitcnt vmcnt(18)
    s_add_u32 m0, s47, 39936
    s_add_u32 s50, s55, s57
    s_add_u32 s50, s50, 32768
    buffer_load_dwordx4 v13, s[16:19], s50 offen nt lds
    s_waitcnt vmcnt(18)
    s_add_u32 m0, s47, 56320
    s_add_u32 s50, s52, s58
    s_add_u32 s50, s50, 49152
    buffer_load_dwordx4 v13, s[16:19], s50 offen nt lds
    s_mov_b32 s61, 0
Lsp_7:
    ds_read_b32 v15, v6 offset:48
    s_waitcnt lgkmcnt(0)
    v_readfirstlane_b32 s60, v15
    s_nop 3
    s_cmp_ge_u32 s60, 8
    s_cbranch_scc1 Lspd_8
    s_sleep 1
    s_add_u32 s61, s61, 1
    s_cmp_lt_u32 s61, 400000
    s_cbranch_scc1 Lsp_7
Lspd_8:
    s_waitcnt vmcnt(15)
    s_add_u32 m0, s47, 8192
    s_add_u32 s50, s54, s56
    s_add_u32 s50, s50, 0
    buffer_load_dwordx4 v12, s[16:19], s50 offen nt lds
    s_add_u32 s50, s97, 98304
    buffer_load_dwordx2 v[108:109], v4, s[24:27], s50 offen offset:2048
    s_waitcnt vmcnt(15)
    s_add_u32 m0, s47, 24576
    s_add_u32 s50, s55, s57
    s_add_u32 s50, s50, 16384
    buffer_load_dwordx4 v12, s[16:19], s50 offen nt lds
    s_add_u32 s50, s97, 98304
    buffer_load_dwordx2 v[110:111], v4, s[24:27], s50 offen offset:3072
    s_waitcnt vmcnt(16)
    s_add_u32 m0, s47, 40960
    s_add_u32 s50, s52, s58
    s_add_u32 s50, s50, 32768
    buffer_load_dwordx4 v12, s[16:19], s50 offen nt lds
    s_add_u32 s50, s97, 102400
    buffer_load_dwordx2 v[112:113], v4, s[24:27], s50 offen offset:0
    s_waitcnt vmcnt(17)
    s_add_u32 m0, s47, 57344
    s_add_u32 s50, s53, s59
    s_add_u32 s50, s50, 49152
    buffer_load_dwordx4 v12, s[16:19], s50 offen nt lds
    s_add_u32 s50, s97, 102400
    buffer_load_dwordx2 v[114:115], v4, s[24:27], s50 offen offset:1024
    s_waitcnt vmcnt(17)
    s_add_u32 m0, s47, 9216
    s_add_u32 s50, s54, s57
    s_add_u32 s50, s50, 0
    buffer_load_dwordx4 v13, s[16:19], s50 offen nt lds
    s_add_u32 s50, s97, 102400
    buffer_load_dwordx2 v[116:117], v4, s[24:27], s50 offen offset:2048
    s_waitcnt vmcnt(18)
    s_add_u32 m0, s47, 25600
    s_add_u32 s50, s55, s58
    s_add_u32 s50, s50, 16384
    buffer_load_dwordx4 v13, s[16:19], s50 offen nt lds
    s_add_u32 s50, s97, 102400
    buffer_load_dwordx2 v[118:119], v4, s[24:27], s50 offen offset:3072
    s_waitcnt vmcnt(19)
    s_add_u32 m0, s47, 41984
    s_add_u32 s50, s52, s59
    s_add_u32 s50, s50, 32768
    buffer_load_dwordx4 v13, s[16:19], s50 offen nt lds
    s_waitcnt vmcnt(18)
    s_add_u32 m0, s47, 58368
    s_add_u32 s50, s53, s56
    s_add_u32 s50, s50, 49152
    buffer_load_dwordx4 v13, s[16:19], s50 offen nt lds
    s_waitcnt vmcnt(18)
    s_add_u32 m0, s47, 10240
    s_add_u32 s50, s54, s58
    s_add_u32 s50, s50, 0
    buffer_load_dwordx4 v12, s[16:19], s50 offen nt lds
    s_waitcnt vmcnt(18)
    s_add_u32 m0, s47, 26624
    s_add_u32 s50, s55, s59
    s_add_u32 s50, s50, 16384
    buffer_load_dwordx4 v12, s[16:19], s50 offen nt lds
    s_waitcnt vmcnt(17)
    s_add_u32 m0, s47, 43008
    s_add_u32 s50, s52, s56
    s_add_u32 s50, s50, 32768
    buffer_load_dwordx4 v12, s[16:19], s50 offen nt lds
    s_waitcnt vmcnt(17)
    s_add_u32 m0, s47, 59392
    s_add_u32 s50, s53, s57
    s_add_u32 s50, s50, 49152
    buffer_load_dwordx4 v12, s[16:19], s50 offen nt lds
    v_mov_b32 v14, 6
    ds_write_b32 v7, v14 offset:0
    s_waitcnt vmcnt(17)
    s_add_u32 m0, s47, 11264
    s_add_u32 s50, s54, s59
    s_add_u32 s50, s50, 0
    buffer_load_dwordx4 v13, s[16:19], s50 offen nt lds
    s_waitcnt vmcnt(16)
    s_add_u32 m0, s47, 27648
    s_add_u32 s50, s55, s56
    s_add_u32 s50, s50, 16384
    buffer_load_dwordx4 v13, s[16:19], s50 offen nt lds
    s_waitcnt vmcnt(15)
    s_add_u32 m0, s47, 44032
    s_add_u32 s50, s52, s57
    s_add_u32 s50, s50, 32768
    buffer_load_dwordx4 v13, s[16:19], s50 offen nt lds
    s_waitcnt vmcnt(14)
    s_add_u32 m0, s47, 60416
    s_add_u32 s50, s53, s58
    s_add_u32 s50, s50, 49152
    buffer_load_dwordx4 v13, s[16:19], s50 offen nt lds
    s_mov_b32 s61, 0
Lsp_9:
    ds_read_b32 v15, v6 offset:52
    s_waitcnt lgkmcnt(0)
    v_readfirstlane_b32 s60, v15
    s_nop 3
    s_cmp_ge_u32 s60, 8
    s_cbranch_scc1 Lspd_10
    s_sleep 1
    s_add_u32 s61, s61, 1
    s_cmp_lt_u32 s61, 400000
    s_cbranch_scc1 Lsp_9
Lspd_10:
    s_waitcnt vmcnt(9)
    s_add_u32 m0, s47, 12288
    s_add_u32 s50, s55, s56
    s_add_u32 s50, s50, 0
    buffer_load_dwordx4 v12, s[16:19], s50 offen nt lds
    s_waitcnt vmcnt(9)
    s_add_u32 m0, s47, 28672
    s_add_u32 s50, s52, s57
    s_add_u32 s50, s50, 16384
    buffer_load_dwordx4 v12, s[16:19], s50 offen nt lds
    s_waitcnt vmcnt(9)
    s_add_u32 m0, s47, 45056
    s_add_u32 s50, s53, s58
    s_add_u32 s50, s50, 32768
    buffer_load_dwordx4 v12, s[16:19], s50 offen nt lds
    s_waitcnt vmcnt(9)
    s_add_u32 m0, s47, 61440
    s_add_u32 s50, s54, s59
    s_add_u32 s50, s50, 49152
    buffer_load_dwordx4 v12, s[16:19], s50 offen nt lds
    s_waitcnt vmcnt(9)
    s_add_u32 m0, s47, 13312
    s_add_u32 s50, s55, s57
    s_add_u32 s50, s50, 0
    buffer_load_dwordx4 v13, s[16:19], s50 offen nt lds
    s_waitcnt vmcnt(9)
    s_add_u32 m0, s47, 29696
    s_add_u32 s50, s52, s58
    s_add_u32 s50, s50, 16384
    buffer_load_dwordx4 v13, s[16:19], s50 offen nt lds
    s_waitcnt vmcnt(9)
    s_add_u32 m0, s47, 46080
    s_add_u32 s50, s53, s59
    s_add_u32 s50, s50, 32768
    buffer_load_dwordx4 v13, s[16:19], s50 offen nt lds
    s_waitcnt vmcnt(9)
    s_add_u32 m0, s47, 62464
    s_add_u32 s50, s54, s56
    s_add_u32 s50, s50, 49152
    buffer_load_dwordx4 v13, s[16:19], s50 offen nt lds
    s_waitcnt vmcnt(9)
    s_add_u32 m0, s47, 14336
    s_add_u32 s50, s55, s58
    s_add_u32 s50, s50, 0
    buffer_load_dwordx4 v12, s[16:19], s50 offen nt lds
    s_waitcnt vmcnt(9)
    s_add_u32 m0, s47, 30720
    s_add_u32 s50, s52, s59
    s_add_u32 s50, s50, 16384
    buffer_load_dwordx4 v12, s[16:19], s50 offen nt lds
    v_mov_b32 v14, 7
    ds_write_b32 v7, v14 offset:0
    s_waitcnt vmcnt(9)
    s_add_u32 m0, s47, 47104
    s_add_u32 s50, s53, s56
    s_add_u32 s50, s50, 32768
    buffer_load_dwordx4 v12, s[16:19], s50 offen nt lds
    s_waitcnt vmcnt(9)
    s_add_u32 m0, s47, 63488
    s_add_u32 s50, s54, s57
    s_add_u32 s50, s50, 49152
    buffer_load_dwordx4 v12, s[16:19], s50 offen nt lds
    s_waitcnt vmcnt(9)
    s_add_u32 m0, s47, 15360
    s_add_u32 s50, s55, s59
    s_add_u32 s50, s50, 0
    buffer_load_dwordx4 v13, s[16:19], s50 offen nt lds
    s_waitcnt vmcnt(9)
    s_add_u32 m0, s47, 31744
    s_add_u32 s50, s52, s56
    s_add_u32 s50, s50, 16384
    buffer_load_dwordx4 v13, s[16:19], s50 offen nt lds
    s_waitcnt vmcnt(9)
    s_add_u32 m0, s47, 48128
    s_add_u32 s50, s53, s57
    s_add_u32 s50, s50, 32768
    buffer_load_dwordx4 v13, s[16:19], s50 offen nt lds
    s_waitcnt vmcnt(9)
    s_add_u32 m0, s47, 64512
    s_add_u32 s50, s54, s58
    s_add_u32 s50, s50, 49152
    buffer_load_dwordx4 v13, s[16:19], s50 offen nt lds
    s_waitcnt vmcnt(26)
    s_branch L_tr2
L_cw:
    s_lshl_b32 s47, s44, 14
    s_and_b32 s52, s43, 1
    s_lshr_b32 s53, s43, 1
    s_lshl_b32 s46, s52, 2
    s_add_u32 s46, s46, s44
    s_and_b32 s46, s46, 7
    s_lshl_b32 s50, s53, 3
    s_add_u32 s46, s46, s50
    v_lshrrev_b32 v14, 2, v1
    v_and_b32 v15, 3, v1
    v_lshlrev_b32 v15, 4, v15
    v_lshl_add_u32 v16, v14, 10, v15
    v_lshl_add_u32 v14, v14, 13, v15
    s_lshl_b32 s50, s46, 18
    s_lshl_b32 s51, s40, 10
    s_add_u32 s50, s50, s51
    s_lshl_b32 s51, s42, 7
    s_add_u32 s50, s50, s51
    s_lshl_b32 s51, s52, 6
    s_add_u32 s50, s50, s51
    s_lshl_b32 s51, s44, 11
    s_add_u32 s62, s51, 131072
    s_lshl_b32 s51, s46, 6
    s_waitcnt lgkmcnt(0)
    s_mov_b32 s20, s70
    s_mov_b32 s21, s71
    s_mov_b32 s22, 4194304
    s_mov_b32 s23, 0x00020000
    s_mov_b32 s8, s64
    s_mov_b32 s9, s65
    s_mov_b32 s10, 32768
    s_mov_b32 s11, 0x00020000
    s_mov_b32 m0, s62
    s_add_u32 s54, s50, 0x20000
    buffer_load_dwordx4 v14, s[20:23], s50 offen  lds
    s_add_u32 m0, s62, 1024
    s_add_u32 s55, s51, 16384
    buffer_load_dwordx4 v14, s[20:23], s54 offen  lds
    s_add_u32 m0, s47, 12288
    s_nop 0
    buffer_load_dwordx4 v16, s[8:11], s51 offen  lds
    s_add_u32 m0, s47, 13312
    s_nop 0
    buffer_load_dwordx4 v16, s[8:11], s55 offen  lds
    s_barrier
    s_mov_b32 s28, s74
    s_mov_b32 s29, s75
    s_mov_b32 s30, 32768
    s_mov_b32 s31, 0x00020000
    s_mov_b32 s36, s78
    s_mov_b32 s37, s79
    s_mov_b32 s38, 268435456
    s_mov_b32 s39, 0x00020000
    v_lshrrev_b32 v24, 2, v2
    v_lshl_add_u32 v24, v3, 3, v24
    v_lshlrev_b32 v24, 6, v24
    v_and_b32 v25, 3, v1
    v_lshl_add_u32 v24, v25, 3, v24
    v_add_u32 v24, s62, v24
    v_lshlrev_b32 v25, 6, v2
    v_lshl_add_u32 v25, v3, 4, v25
    v_add_u32 v25, s47, v25
    v_lshlrev_b32 v27, 4, v1
    v_add_u32 v27, s47, v27
    v_mov_b32 v20, 149056
    v_mov_b32 v21, 1
    s_lshr_b32 s50, s44, 2
    s_lshl_b32 s50, s50, 2
    v_add_u32 v19, s50, v20
    v_lshlrev_b32 v16, 13, v3
    v_lshl_add_u32 v16, v2, 4, v16
    s_lshl_b32 s50, s45, 15
    s_lshl_b32 s51, s43, 11
    s_add_u32 s50, s50, s51
    s_lshl_b32 s51, s44, 8
    s_add_u32 s50, s50, s51
    s_add_u32 s50, s50, 1048576
    v_add_u32 v16, s50, v16
    v_lshlrev_b32 v17, 8, v2
    v_lshl_add_u32 v17, v3, 4, v17
    v_add_u32 v17, 151552, v17
    v_mov_b32 v18, 148992
    v_xor_b32 v12, v2, v3
    v_lshlrev_b32 v12, 4, v12
    v_lshlrev_b32 v13, 8, v2
    v_add_u32 v13, s47, v13
    v_add_u32 v28, v13, v12
    v_xor_b32 v29, 64, v12
    v_add_u32 v29, v13, v29
    v_xor_b32 v30, 0x80, v12
    v_add_u32 v30, v13, v30
    v_xor_b32 v31, 0xc0, v12
    v_add_u32 v31, v13, v31
    v_mov_b32 v160, 0
    v_mov_b32 v161, 0
    v_mov_b32 v162, 0
    v_mov_b32 v163, 0
    s_waitcnt vmcnt(0)
    ds_read_b64_tr_b16 v[104:105], v24 offset:0
    ds_read_b64_tr_b16 v[106:107], v24 offset:256
    ds_read_b64_tr_b16 v[108:109], v24 offset:32
    ds_read_b64_tr_b16 v[110:111], v24 offset:288
    ds_read_b128 v[96:99], v25 offset:12288
    ds_read_b128 v[100:103], v25 offset:13312
    s_waitcnt lgkmcnt(0)
    v_mfma_f32_16x16x32_bf16 v[112:115], v[104:107], v[96:99], 0
    v_mfma_f32_16x16x32_bf16 v[116:119], v[104:107], v[100:103], 0
    v_mfma_f32_16x16x32_bf16 v[120:123], v[108:111], v[96:99], 0
    v_mfma_f32_16x16x32_bf16 v[124:127], v[108:111], v[100:103], 0
    s_nop 7
    ds_write_b128 v27, v[112:115] offset:12288
    ds_write_b128 v27, v[116:119] offset:13312
    ds_write_b128 v27, v[120:123] offset:14336
    ds_write_b128 v27, v[124:127] offset:15360
    s_waitcnt lgkmcnt(0)
    s_mov_b64 exec, 1
    ds_add_u32 v20, v21 offset:8
    s_mov_b64 exec, -1
    s_mov_b32 s61, 0
Lsp_11:
    ds_read_b32 v22, v19 offset:0
    s_waitcnt lgkmcnt(0)
    v_readfirstlane_b32 s60, v22
    s_nop 3
    s_cmp_ge_u32 s60, 1
    s_cbranch_scc1 Lspd_12
    s_sleep 2
    s_add_u32 s61, s61, 1
    s_cmp_lt_u32 s61, 400000
    s_cbranch_scc1 Lsp_11
Lspd_12:
    ds_read_b128 v[32:35], v28 offset:0
    ds_read_b128 v[36:39], v29 offset:0
    ds_read_b128 v[40:43], v30 offset:0
    ds_read_b128 v[44:47], v31 offset:0
    s_waitcnt lgkmcnt(0)
    s_mov_b64 exec, 1
    ds_add_u32 v20, v21 offset:40
    s_mov_b64 exec, -1
    s_mov_b32 s61, 0
Lsp_13:
    ds_read_b32 v22, v19 offset:0
    s_waitcnt lgkmcnt(0)
    v_readfirstlane_b32 s60, v22
    s_nop 3
    s_cmp_ge_u32 s60, 2
    s_cbranch_scc1 Lspd_14
    s_sleep 2
    s_add_u32 s61, s61, 1
    s_cmp_lt_u32 s61, 400000
    s_cbranch_scc1 Lsp_13
Lspd_14:
    ds_read_b128 v[48:51], v28 offset:4096
    ds_read_b128 v[52:55], v29 offset:4096
    ds_read_b128 v[56:59], v30 offset:4096
    ds_read_b128 v[60:63], v31 offset:4096
    s_waitcnt lgkmcnt(0)
    s_mov_b64 exec, 1
    ds_add_u32 v20, v21 offset:44
    s_mov_b64 exec, -1
    s_mov_b32 s61, 0
Lsp_15:
    ds_read_b32 v22, v19 offset:0
    s_waitcnt lgkmcnt(0)
    v_readfirstlane_b32 s60, v22
    s_nop 3
    s_cmp_ge_u32 s60, 3
    s_cbranch_scc1 Lspd_16
    s_sleep 2
    s_add_u32 s61, s61, 1
    s_cmp_lt_u32 s61, 400000
    s_cbranch_scc1 Lsp_15
Lspd_16:
    ds_read_b128 v[64:67], v28 offset:8192
    ds_read_b128 v[68:71], v29 offset:8192
    ds_read_b128 v[72:75], v30 offset:8192
    ds_read_b128 v[76:79], v31 offset:8192
    s_waitcnt lgkmcnt(0)
    s_mov_b64 exec, 1
    ds_add_u32 v20, v21 offset:48
    s_mov_b64 exec, -1
    s_mov_b32 s61, 0
Lsp_17:
    ds_read_b32 v22, v19 offset:0
    s_waitcnt lgkmcnt(0)
    v_readfirstlane_b32 s60, v22
    s_nop 3
    s_cmp_ge_u32 s60, 4
    s_cbranch_scc1 Lspd_18
    s_sleep 2
    s_add_u32 s61, s61, 1
    s_cmp_lt_u32 s61, 400000
    s_cbranch_scc1 Lsp_17
Lspd_18:
    ds_read_b128 v[80:83], v28 offset:12288
    ds_read_b128 v[84:87], v29 offset:12288
    ds_read_b128 v[88:91], v30 offset:12288
    ds_read_b128 v[92:95], v31 offset:12288
    s_waitcnt lgkmcnt(0)
    s_mov_b64 exec, 1
    ds_add_u32 v20, v21 offset:52
    s_mov_b64 exec, -1
    s_mov_b32 s61, 0
Lsp_19:
    ds_read_b32 v22, v20 offset:16
    s_waitcnt lgkmcnt(0)
    v_readfirstlane_b32 s60, v22
    s_nop 3
    s_cmp_ge_u32 s60, 1
    s_cbranch_scc1 Lspd_20
    s_sleep 2
    s_add_u32 s61, s61, 1
    s_cmp_lt_u32 s61, 400000
    s_cbranch_scc1 Lsp_19
Lspd_20:
    s_mov_b32 s94, s60
    ds_read_b128 v[96:99], v17 offset:0
    ds_read_b128 v[100:103], v17 offset:64
    ds_read_b128 v[104:107], v17 offset:128
    ds_read_b128 v[108:111], v17 offset:192
    ds_read_b64 v[22:23], v18
    s_waitcnt lgkmcnt(4)
    v_mfma_f32_16x16x32_bf16 v[112:115], v[32:35], v[96:99], 0
    v_mfma_f32_16x16x32_bf16 v[116:119], v[48:51], v[96:99], 0
    v_mfma_f32_16x16x32_bf16 v[120:123], v[64:67], v[96:99], 0
    v_mfma_f32_16x16x32_bf16 v[124:127], v[80:83], v[96:99], 0
    s_waitcnt lgkmcnt(3)
    v_mfma_f32_16x16x32_bf16 v[112:115], v[36:39], v[100:103], v[112:115]
    v_mfma_f32_16x16x32_bf16 v[116:119], v[52:55], v[100:103], v[116:119]
    v_mfma_f32_16x16x32_bf16 v[120:123], v[68:71], v[100:103], v[120:123]
    v_mfma_f32_16x16x32_bf16 v[124:127], v[84:87], v[100:103], v[124:127]
    s_waitcnt lgkmcnt(2)
    v_mfma_f32_16x16x32_bf16 v[112:115], v[40:43], v[104:107], v[112:115]
    v_mfma_f32_16x16x32_bf16 v[116:119], v[56:59], v[104:107], v[116:119]
    v_mfma_f32_16x16x32_bf16 v[120:123], v[72:75], v[104:107], v[120:123]
    v_mfma_f32_16x16x32_bf16 v[124:127], v[88:91], v[104:107], v[124:127]
    s_waitcnt lgkmcnt(1)
    v_mfma_f32_16x16x32_bf16 v[112:115], v[44:47], v[108:111], v[112:115]
    v_mfma_f32_16x16x32_bf16 v[116:119], v[60:63], v[108:111], v[116:119]
    v_mfma_f32_16x16x32_bf16 v[120:123], v[76:79], v[108:111], v[120:123]
    v_mfma_f32_16x16x32_bf16 v[124:127], v[92:95], v[108:111], v[124:127]
    s_waitcnt lgkmcnt(0)
    v_and_b32 v4, 2047, v22
    v_bfe_u32 v5, v22, 11, 11
    v_alignbit_b32 v6, v23, v22, 22
    v_and_b32 v6, 2047, v6
    v_bfe_u32 v7, v23, 1, 11
    s_mov_b32 s50, 0x3db504f3
    s_mov_b32 s51, 0xffff0000
    s_mov_b32 s99, 0x3fb8aa3b
    s_nop 1
    v_cvt_pk_bf16_f32 v128, v112, v113
    v_lshlrev_b32 v112, 16, v128
    v_and_b32 v113, s51, v128
    v_mul_f32 v112, s50, v112
    v_mul_f32 v113, s50, v113
    v_cvt_pk_bf16_f32 v128, v112, v113
    v_lshlrev_b32 v112, 16, v128
    v_and_b32 v113, s51, v128
    v_cvt_pk_bf16_f32 v128, v114, v115
    v_lshlrev_b32 v114, 16, v128
    v_and_b32 v115, s51, v128
    v_mul_f32 v114, s50, v114
    v_mul_f32 v115, s50, v115
    v_cvt_pk_bf16_f32 v128, v114, v115
    v_lshlrev_b32 v114, 16, v128
    v_and_b32 v115, s51, v128
    v_cvt_pk_bf16_f32 v128, v116, v117
    v_lshlrev_b32 v116, 16, v128
    v_and_b32 v117, s51, v128
    v_mul_f32 v116, s50, v116
    v_mul_f32 v117, s50, v117
    v_cvt_pk_bf16_f32 v128, v116, v117
    v_lshlrev_b32 v116, 16, v128
    v_and_b32 v117, s51, v128
    v_cvt_pk_bf16_f32 v128, v118, v119
    v_lshlrev_b32 v118, 16, v128
    v_and_b32 v119, s51, v128
    v_mul_f32 v118, s50, v118
    v_mul_f32 v119, s50, v119
    v_cvt_pk_bf16_f32 v128, v118, v119
    v_lshlrev_b32 v118, 16, v128
    v_and_b32 v119, s51, v128
    v_cvt_pk_bf16_f32 v128, v120, v121
    v_lshlrev_b32 v120, 16, v128
    v_and_b32 v121, s51, v128
    v_mul_f32 v120, s50, v120
    v_mul_f32 v121, s50, v121
    v_cvt_pk_bf16_f32 v128, v120, v121
    v_lshlrev_b32 v120, 16, v128
    v_and_b32 v121, s51, v128
    v_cvt_pk_bf16_f32 v128, v122, v123
    v_lshlrev_b32 v122, 16, v128
    v_and_b32 v123, s51, v128
    v_mul_f32 v122, s50, v122
    v_mul_f32 v123, s50, v123
    v_cvt_pk_bf16_f32 v128, v122, v123
    v_lshlrev_b32 v122, 16, v128
    v_and_b32 v123, s51, v128
    v_cvt_pk_bf16_f32 v128, v124, v125
    v_lshlrev_b32 v124, 16, v128
    v_and_b32 v125, s51, v128
    v_mul_f32 v124, s50, v124
    v_mul_f32 v125, s50, v125
    v_cvt_pk_bf16_f32 v128, v124, v125
    v_lshlrev_b32 v124, 16, v128
    v_and_b32 v125, s51, v128
    v_cvt_pk_bf16_f32 v128, v126, v127
    v_lshlrev_b32 v126, 16, v128
    v_and_b32 v127, s51, v128
    v_mul_f32 v126, s50, v126
    v_mul_f32 v127, s50, v127
    v_cvt_pk_bf16_f32 v128, v126, v127
    v_lshlrev_b32 v126, 16, v128
    v_and_b32 v127, s51, v128
    v_max3_f32 v128, v112, v113, v114
    v_max3_f32 v128, v128, v115, v116
    v_max3_f32 v128, v128, v117, v118
    v_max3_f32 v128, v128, v119, v120
    v_max3_f32 v128, v128, v121, v122
    v_max3_f32 v128, v128, v123, v124
    v_max3_f32 v128, v128, v125, v126
    v_max_f32 v128, v128, v127
    v_mov_b32 v129, v128
    s_nop 1
    v_permlane32_swap_b32 v128, v129
    s_nop 0
    v_max_f32 v128, v128, v129
    v_mov_b32 v129, v128
    s_nop 1
    v_permlane16_swap_b32 v128, v129
    s_nop 0
    v_max_f32 v128, v128, v129
    v_lshlrev_b32 v12, 5, v2
    v_add_u32 v12, 147456, v12
    s_lshl_b32 s50, s44, 2
    v_add_u32 v13, s50, v12
    ds_write_b32 v13, v128
    s_waitcnt lgkmcnt(0)
    s_mov_b64 exec, 1
    ds_add_u32 v20, v21 offset:20
    s_mov_b64 exec, -1
    s_mov_b32 s61, 0
Lsp_21:
    ds_read_b32 v22, v20 offset:20
    s_waitcnt lgkmcnt(0)
    v_readfirstlane_b32 s60, v22
    s_nop 3
    s_cmp_ge_u32 s60, 8
    s_cbranch_scc1 Lspd_22
    s_sleep 1
    s_add_u32 s61, s61, 1
    s_cmp_lt_u32 s61, 400000
    s_cbranch_scc1 Lsp_21
Lspd_22:
    ds_read_b128 v[132:135], v12
    ds_read_b128 v[136:139], v12 offset:16
    s_waitcnt lgkmcnt(0)
    v_max3_f32 v128, v132, v133, v134
    v_max3_f32 v128, v128, v135, v136
    v_max3_f32 v128, v128, v137, v138
    v_max_f32 v128, v128, v139
    v_mul_f32 v23, s99, v128
    v_fma_f32 v112, v112, s99, -v23
    v_fma_f32 v113, v113, s99, -v23
    v_fma_f32 v114, v114, s99, -v23
    v_fma_f32 v115, v115, s99, -v23
    v_fma_f32 v116, v116, s99, -v23
    v_fma_f32 v117, v117, s99, -v23
    v_fma_f32 v118, v118, s99, -v23
    v_fma_f32 v119, v119, s99, -v23
    v_fma_f32 v120, v120, s99, -v23
    v_fma_f32 v121, v121, s99, -v23
    v_fma_f32 v122, v122, s99, -v23
    v_fma_f32 v123, v123, s99, -v23
    v_fma_f32 v124, v124, s99, -v23
    v_fma_f32 v125, v125, s99, -v23
    v_fma_f32 v126, v126, s99, -v23
    v_fma_f32 v127, v127, s99, -v23
    v_exp_f32 v112, v112
    v_exp_f32 v113, v113
    v_exp_f32 v114, v114
    v_exp_f32 v115, v115
    v_exp_f32 v116, v116
    v_exp_f32 v117, v117
    v_exp_f32 v118, v118
    v_exp_f32 v119, v119
    v_exp_f32 v120, v120
    v_exp_f32 v121, v121
    v_exp_f32 v122, v122
    v_exp_f32 v123, v123
    v_exp_f32 v124, v124
    v_exp_f32 v125, v125
    v_exp_f32 v126, v126
    v_exp_f32 v127, v127
    s_nop 0
    v_lshlrev_b32 v14, 3, v1
    v_add_u32 v14, s62, v14
    v_cvt_pk_bf16_f32 v128, v112, v113
    v_cvt_pk_bf16_f32 v129, v114, v115
    ds_write_b64 v14, v[128:129] offset:0
    v_cvt_pk_bf16_f32 v130, v116, v117
    v_cvt_pk_bf16_f32 v131, v118, v119
    ds_write_b64 v14, v[130:131] offset:512
    v_cvt_pk_bf16_f32 v132, v120, v121
    v_cvt_pk_bf16_f32 v133, v122, v123
    ds_write_b64 v14, v[132:133] offset:1024
    v_cvt_pk_bf16_f32 v134, v124, v125
    v_cvt_pk_bf16_f32 v135, v126, v127
    ds_write_b64 v14, v[134:135] offset:1536
    v_pk_add_f32 v[112:113], v[112:113], v[120:121]
    v_pk_add_f32 v[114:115], v[114:115], v[122:123]
    v_pk_add_f32 v[116:117], v[116:117], v[124:125]
    v_pk_add_f32 v[118:119], v[118:119], v[126:127]
    v_pk_add_f32 v[112:113], v[112:113], v[116:117]
    v_pk_add_f32 v[114:115], v[114:115], v[118:119]
    v_pk_add_f32 v[112:113], v[112:113], v[114:115]
    v_add_f32 v112, v112, v113
    v_mov_b32 v113, v112
    s_nop 1
    v_permlane32_swap_b32 v112, v113
    s_nop 0
    v_add_f32 v112, v112, v113
    v_mov_b32 v113, v112
    s_nop 1
    v_permlane16_swap_b32 v112, v113
    s_nop 0
    v_add_f32 v112, v112, v113
    ds_write_b32 v13, v112 offset:512
    s_waitcnt lgkmcnt(0)
    s_mov_b64 exec, 1
    ds_add_u32 v20, v21 offset:24
    s_mov_b64 exec, -1
    v_lshrrev_b32 v24, 2, v2
    v_lshl_add_u32 v24, v3, 2, v24
    v_and_b32 v25, 7, v24
    v_lshlrev_b32 v25, 1, v25
    v_bfe_u32 v27, v1, 1, 1
    s_lshl_b32 s50, s44, 1
    v_add_u32 v27, s50, v27
    v_xor_b32 v25, v25, v27
    v_lshlrev_b32 v25, 4, v25
    v_lshl_add_u32 v25, v24, 8, v25
    v_and_b32 v27, 1, v1
    v_lshl_add_u32 v25, v27, 3, v25
    v_add_u32 v26, 0x10000, v25
    v_lshlrev_b32 v27, 3, v1
    v_add_u32 v27, 131072, v27
    v_and_b32 v30, 1, v3
    v_lshlrev_b32 v30, 4, v30
    v_cmp_le_u32 s[6:7], 2, v3
    v_lshlrev_b32 v19, 4, v3
    v_add_u32 v19, 148480, v19
    s_mov_b32 s98, 4294965248
    s_mov_b32 s61, 0
Lsp_23:
    ds_read_b32 v22, v20 offset:24
    s_waitcnt lgkmcnt(0)
    v_readfirstlane_b32 s60, v22
    s_nop 3
    s_cmp_ge_u32 s60, 8
    s_cbranch_scc1 Lspd_24
    s_sleep 1
    s_add_u32 s61, s61, 1
    s_cmp_lt_u32 s61, 400000
    s_cbranch_scc1 Lsp_23
Lspd_24:
    s_cmp_lg_u32 s44, 1
    s_cbranch_scc1 Lnp_25
    ds_read_b128 v[136:139], v12 offset:512
    ds_read_b128 v[140:143], v12 offset:528
    ds_read_b64 v[146:147], v18
    v_lshlrev_b32 v149, 4, v2
    s_lshl_b32 s50, s45, 10
    s_add_u32 s50, s50, 524288
    s_lshl_b32 s51, s43, 8
    s_add_u32 s51, s51, s50
    v_mov_b32 v144, v23
    s_waitcnt lgkmcnt(0)
    v_pk_add_f32 v[136:137], v[136:137], v[138:139]
    v_pk_add_f32 v[140:141], v[140:141], v[142:143]
    v_pk_add_f32 v[136:137], v[136:137], v[140:141]
    v_add_f32 v145, v136, v137
    s_mov_b64 exec, 0xffff
    s_add_u32 s55, s51, s3
    buffer_store_dwordx4 v[144:147], v149, s[36:39], s55 offen
    s_cmp_eq_u32 s94, 2
    s_cbranch_scc1 L_std
    buffer_store_dwordx4 v[144:147], v149, s[36:39], s51 offen sc1
L_std:
    s_mov_b64 exec, -1
Lnp_25:
    ds_read2st64_b64 v[32:35], v27 offset0:0 offset1:4
    ds_read2st64_b64 v[36:39], v27 offset0:8 offset1:12
    ds_read2st64_b64 v[40:43], v27 offset0:16 offset1:20
    ds_read2st64_b64 v[44:47], v27 offset0:24 offset1:28
    ds_read2st64_b64 v[48:51], v27 offset0:1 offset1:5
    ds_read2st64_b64 v[52:55], v27 offset0:9 offset1:13
    ds_read2st64_b64 v[56:59], v27 offset0:17 offset1:21
    ds_read2st64_b64 v[60:63], v27 offset0:25 offset1:29
    s_waitcnt lgkmcnt(0)
    ds_read2st64_b64 v[64:67], v27 offset0:2 offset1:6
    ds_read2st64_b64 v[68:71], v27 offset0:10 offset1:14
    ds_read2st64_b64 v[72:75], v27 offset0:18 offset1:22
    ds_read2st64_b64 v[76:79], v27 offset0:26 offset1:30
    ds_read2st64_b64 v[80:83], v27 offset0:3 offset1:7
    ds_read2st64_b64 v[84:87], v27 offset0:11 offset1:15
    ds_read2st64_b64 v[88:91], v27 offset0:19 offset1:23
    ds_read2st64_b64 v[92:95], v27 offset0:27 offset1:31
    s_mov_b32 s61, 0
Lsp_26:
    ds_read_b64 v[22:23], v20 offset:0
    s_waitcnt lgkmcnt(0)
    v_min_u32 v22, v22, v23
    s_nop 0
    v_readfirstlane_b32 s60, v22
    s_nop 3
    s_cmp_ge_u32 s60, 5
    s_cbranch_scc1 Lspd_27
    s_sleep 2
    s_add_u32 s61, s61, 1
    s_cmp_lt_u32 s61, 400000
    s_cbranch_scc1 Lsp_26
Lspd_27:
    ds_read_b64_tr_b16 v[112:113], v25 offset:0
    ds_read_b64_tr_b16 v[114:115], v25 offset:16384
    ds_read_b64_tr_b16 v[116:117], v25 offset:32768
    ds_read_b64_tr_b16 v[118:119], v25 offset:49152
    ds_read_b64_tr_b16 v[120:121], v26 offset:0
    ds_read_b64_tr_b16 v[122:123], v26 offset:16384
    ds_read_b64_tr_b16 v[124:125], v26 offset:32768
    ds_read_b64_tr_b16 v[126:127], v26 offset:49152
    s_waitcnt lgkmcnt(6)
    v_mfma_f32_16x16x32_bf16 v[160:163], v[32:35], v[112:115], 0
    s_waitcnt lgkmcnt(4)
    v_mfma_f32_16x16x32_bf16 v[160:163], v[36:39], v[116:119], v[160:163]
    s_waitcnt lgkmcnt(2)
    v_mfma_f32_16x16x32_bf16 v[160:163], v[40:43], v[120:123], v[160:163]
    s_waitcnt lgkmcnt(0)
    v_mfma_f32_16x16x32_bf16 v[160:163], v[44:47], v[124:127], v[160:163]
    s_mov_b32 s61, 0
Lsp_28:
    ds_read_b64 v[22:23], v20 offset:0
    s_waitcnt lgkmcnt(0)
    v_min_u32 v22, v22, v23
    s_nop 0
    v_readfirstlane_b32 s60, v22
    s_nop 3
    s_cmp_ge_u32 s60, 6
    s_cbranch_scc1 Lspd_29
    s_sleep 2
    s_add_u32 s61, s61, 1
    s_cmp_lt_u32 s61, 400000
    s_cbranch_scc1 Lsp_28
Lspd_29:
    ds_read_b64_tr_b16 v[112:113], v25 offset:4096
    ds_read_b64_tr_b16 v[114:115], v25 offset:20480
    ds_read_b64_tr_b16 v[116:117], v25 offset:36864
    ds_read_b64_tr_b16 v[118:119], v25 offset:53248
    ds_read_b64_tr_b16 v[120:121], v26 offset:4096
    ds_read_b64_tr_b16 v[122:123], v26 offset:20480
    ds_read_b64_tr_b16 v[124:125], v26 offset:36864
    ds_read_b64_tr_b16 v[126:127], v26 offset:53248
    s_waitcnt lgkmcnt(6)
    v_mfma_f32_16x16x32_bf16 v[160:163], v[48:51], v[112:115], v[160:163]
    s_waitcnt lgkmcnt(4)
    v_mfma_f32_16x16x32_bf16 v[160:163], v[52:55], v[116:119], v[160:163]
    s_waitcnt lgkmcnt(2)
    v_mfma_f32_16x16x32_bf16 v[160:163], v[56:59], v[120:123], v[160:163]
    s_waitcnt lgkmcnt(0)
    v_mfma_f32_16x16x32_bf16 v[160:163], v[60:63], v[124:127], v[160:163]
    s_mov_b32 s61, 0
Lsp_30:
    ds_read_b64 v[22:23], v20 offset:0
    s_waitcnt lgkmcnt(0)
    v_min_u32 v22, v22, v23
    s_nop 0
    v_readfirstlane_b32 s60, v22
    s_nop 3
    s_cmp_ge_u32 s60, 7
    s_cbranch_scc1 Lspd_31
    s_sleep 2
    s_add_u32 s61, s61, 1
    s_cmp_lt_u32 s61, 400000
    s_cbranch_scc1 Lsp_30
Lspd_31:
    ds_read_b64_tr_b16 v[112:113], v25 offset:8192
    ds_read_b64_tr_b16 v[114:115], v25 offset:24576
    ds_read_b64_tr_b16 v[116:117], v25 offset:40960
    ds_read_b64_tr_b16 v[118:119], v25 offset:57344
    ds_read_b64_tr_b16 v[120:121], v26 offset:8192
    ds_read_b64_tr_b16 v[122:123], v26 offset:24576
    ds_read_b64_tr_b16 v[124:125], v26 offset:40960
    ds_read_b64_tr_b16 v[126:127], v26 offset:57344
    s_waitcnt lgkmcnt(6)
    v_mfma_f32_16x16x32_bf16 v[160:163], v[64:67], v[112:115], v[160:163]
    s_waitcnt lgkmcnt(4)
    v_mfma_f32_16x16x32_bf16 v[160:163], v[68:71], v[116:119], v[160:163]
    s_waitcnt lgkmcnt(2)
    v_mfma_f32_16x16x32_bf16 v[160:163], v[72:75], v[120:123], v[160:163]
    s_waitcnt lgkmcnt(0)
    v_mfma_f32_16x16x32_bf16 v[160:163], v[76:79], v[124:127], v[160:163]
    s_mov_b32 s61, 0
Lsp_32:
    ds_read_b32 v22, v20 offset:60
    s_waitcnt lgkmcnt(0)
    v_readfirstlane_b32 s60, v22
    s_nop 3
    s_cmp_ge_u32 s60, 1
    s_cbranch_scc1 Lspd_33
    s_sleep 1
    s_add_u32 s61, s61, 1
    s_cmp_lt_u32 s61, 400000
    s_cbranch_scc1 Lsp_32
Lspd_33:
    s_mov_b32 s61, 0
Lsp_34:
    ds_read_b64 v[22:23], v20 offset:0
    s_waitcnt lgkmcnt(0)
    v_min_u32 v22, v22, v23
    s_nop 0
    v_readfirstlane_b32 s60, v22
    s_nop 3
    s_cmp_ge_u32 s60, 8
    s_cbranch_scc1 Lspd_35
    s_add_u32 s61, s61, 1
    s_cmp_lt_u32 s61, 400000
    s_cbranch_scc1 Lsp_34
Lspd_35:
    ds_read_b64_tr_b16 v[112:113], v25 offset:12288
    ds_read_b64_tr_b16 v[114:115], v25 offset:28672
    ds_read_b64_tr_b16 v[116:117], v25 offset:45056
    ds_read_b64_tr_b16 v[118:119], v25 offset:61440
    ds_read_b64_tr_b16 v[120:121], v26 offset:12288
    ds_read_b64_tr_b16 v[122:123], v26 offset:28672
    ds_read_b64_tr_b16 v[124:125], v26 offset:45056
    ds_read_b64_tr_b16 v[126:127], v26 offset:61440
    s_waitcnt lgkmcnt(6)
    v_mfma_f32_16x16x32_bf16 v[160:163], v[80:83], v[112:115], v[160:163]
    s_waitcnt lgkmcnt(4)
    v_mfma_f32_16x16x32_bf16 v[160:163], v[84:87], v[116:119], v[160:163]
    s_waitcnt lgkmcnt(2)
    v_mfma_f32_16x16x32_bf16 v[160:163], v[88:91], v[120:123], v[160:163]
    s_waitcnt lgkmcnt(0)
    v_mfma_f32_16x16x32_bf16 v[160:163], v[92:95], v[124:127], v[160:163]
    s_nop 7
    v_and_or_b32 v160, v160, s98, v4
    v_and_or_b32 v161, v161, s98, v5
    v_and_or_b32 v162, v162, s98, v6
    v_and_or_b32 v163, v163, s98, v7
    buffer_store_dwordx4 v[160:163], v16, s[36:39], s3 offen
    s_cmp_eq_u32 s94, 2
    s_cbranch_scc1 Lsd_36
    buffer_store_dwordx4 v[160:163], v16, s[36:39], 0 offen sc1
Lsd_36:
    s_cmp_lg_u32 s44, 0
    s_cbranch_scc1 Lend_37
    v_lshlrev_b32 v24, 4, v1
    s_lshl_b32 s50, s42, 18
    s_lshl_b32 s51, s63, 5
    s_add_u32 s50, s50, s51
    s_add_u32 s50, s50, 3145728
    s_add_u32 s51, s50, 4096
    v_lshlrev_b32 v25, 10, v3
    v_and_b32 v26, 1, v2
    v_lshl_add_u32 v25, v26, 1, v25
    v_bfe_u32 v26, v2, 1, 2
    v_lshl_add_u32 v25, v26, 3, v25
    v_lshrrev_b32 v26, 3, v2
    v_lshl_add_u32 v25, v26, 2, v25
    s_lshl_b32 s96, s42, 12
    s_lshr_b32 s97, s63, 3
    s_add_u32 s96, s96, s97
    s_barrier
    s_mov_b32 s61, 0
Lsp_38:
    ds_read_b32 v22, v20 offset:56
    s_waitcnt lgkmcnt(0)
    v_readfirstlane_b32 s60, v22
    s_nop 3
    s_cmp_ge_u32 s60, 4
    s_cbranch_scc1 Lspd_39
    s_sleep 1
    s_add_u32 s61, s61, 1
    s_cmp_lt_u32 s61, 400000
    s_cbranch_scc1 Lsp_38
Lspd_39:
    s_mov_b32 s61, 0
Lm2l_40:
    buffer_load_dwordx4 v[32:35], v24, s[36:39], s50 offen offset:0 sc1
    buffer_load_dwordx4 v[36:39], v24, s[36:39], s50 offen offset:1024 sc1
    buffer_load_dwordx4 v[40:43], v24, s[36:39], s50 offen offset:2048 sc1
    buffer_load_dwordx4 v[44:47], v24, s[36:39], s50 offen offset:3072 sc1
    buffer_load_dwordx4 v[48:51], v24, s[36:39], s51 offen offset:0 sc1
    buffer_load_dwordx4 v[52:55], v24, s[36:39], s51 offen offset:1024 sc1
    buffer_load_dwordx4 v[56:59], v24, s[36:39], s51 offen offset:2048 sc1
    buffer_load_dwordx4 v[60:63], v24, s[36:39], s51 offen offset:3072 sc1
    s_waitcnt vmcnt(0)
    v_xor_b32 v32, v32, v4
    v_xor_b32 v33, v33, v5
    v_xor_b32 v34, v34, v6
    v_xor_b32 v35, v35, v7
    v_xor_b32 v36, v36, v4
    v_xor_b32 v37, v37, v5
    v_xor_b32 v38, v38, v6
    v_xor_b32 v39, v39, v7
    v_xor_b32 v40, v40, v4
    v_xor_b32 v41, v41, v5
    v_xor_b32 v42, v42, v6
    v_xor_b32 v43, v43, v7
    v_xor_b32 v44, v44, v4
    v_xor_b32 v45, v45, v5
    v_xor_b32 v46, v46, v6
    v_xor_b32 v47, v47, v7
    v_xor_b32 v48, v48, v4
    v_xor_b32 v49, v49, v5
    v_xor_b32 v50, v50, v6
    v_xor_b32 v51, v51, v7
    v_xor_b32 v52, v52, v4
    v_xor_b32 v53, v53, v5
    v_xor_b32 v54, v54, v6
    v_xor_b32 v55, v55, v7
    v_xor_b32 v56, v56, v4
    v_xor_b32 v57, v57, v5
    v_xor_b32 v58, v58, v6
    v_xor_b32 v59, v59, v7
    v_xor_b32 v60, v60, v4
    v_xor_b32 v61, v61, v5
    v_xor_b32 v62, v62, v6
    v_xor_b32 v63, v63, v7
    v_or3_b32 v28, v32, v33, v34
    v_or3_b32 v28, v28, v35, v36
    v_or3_b32 v28, v28, v37, v38
    v_or3_b32 v28, v28, v39, v40
    v_or3_b32 v28, v28, v41, v42
    v_or3_b32 v28, v28, v43, v44
    v_or3_b32 v28, v28, v45, v46
    v_or3_b32 v28, v28, v47, v48
    v_or3_b32 v28, v28, v49, v50
    v_or3_b32 v28, v28, v51, v52
    v_or3_b32 v28, v28, v53, v54
    v_or3_b32 v28, v28, v55, v56
    v_or3_b32 v28, v28, v57, v58
    v_or3_b32 v28, v28, v59, v60
    v_or3_b32 v28, v28, v61, v62
    v_or_b32 v28, v28, v63
    v_and_b32 v28, 2047, v28
    v_cmp_eq_u32 vcc, 0, v28
    s_nop 3
    s_cmp_eq_u64 vcc, -1
    s_cbranch_scc1 Lm2g_41
    s_add_u32 s61, s61, 1
    s_cmp_lt_u32 s61, 20000
    s_cbranch_scc1 Lm2l_40
Lm2g_41:
    v_pk_add_f32 v[32:33], v[32:33], v[48:49]
    v_pk_add_f32 v[34:35], v[34:35], v[50:51]
    v_pk_add_f32 v[36:37], v[36:37], v[52:53]
    v_pk_add_f32 v[38:39], v[38:39], v[54:55]
    v_pk_add_f32 v[40:41], v[40:41], v[56:57]
    v_pk_add_f32 v[42:43], v[42:43], v[58:59]
    v_pk_add_f32 v[44:45], v[44:45], v[60:61]
    v_pk_add_f32 v[46:47], v[46:47], v[62:63]
    v_pk_add_f32 v[32:33], v[32:33], v[40:41]
    v_pk_add_f32 v[34:35], v[34:35], v[42:43]
    v_pk_add_f32 v[36:37], v[36:37], v[44:45]
    v_pk_add_f32 v[38:39], v[38:39], v[46:47]
    v_pk_add_f32 v[32:33], v[32:33], v[36:37]
    v_pk_add_f32 v[34:35], v[34:35], v[38:39]
    v_mov_b32 v36, v32
    v_mov_b32 v37, v33
    v_mov_b32 v38, v34
    v_mov_b32 v39, v35
    s_nop 0
    v_permlane32_swap_b32 v32, v36
    v_permlane32_swap_b32 v33, v37
    v_permlane32_swap_b32 v34, v38
    v_permlane32_swap_b32 v35, v39
    s_nop 0
    v_pk_add_f32 v[32:33], v[32:33], v[36:37]
    v_pk_add_f32 v[34:35], v[34:35], v[38:39]
    v_mov_b32 v36, v32
    v_mov_b32 v37, v33
    v_mov_b32 v38, v34
    v_mov_b32 v39, v35
    s_nop 0
    v_permlane16_swap_b32 v32, v36
    v_permlane16_swap_b32 v33, v37
    v_permlane16_swap_b32 v34, v38
    v_permlane16_swap_b32 v35, v39
    s_nop 0
    v_pk_add_f32 v[32:33], v[32:33], v[36:37]
    v_pk_add_f32 v[34:35], v[34:35], v[38:39]
    v_cvt_pk_bf16_f32 v28, v32, v33
    v_cvt_pk_bf16_f32 v29, v34, v35
    s_nop 0
    v_cndmask_b32 v28, v28, v29, s[6:7]
    v_lshrrev_b32 v28, v30, v28
    buffer_store_short v28, v25, s[28:31], s96 offen
Lend_37:
    s_endpgm
L_op:
    s_setprio 3
    v_mov_b32 v5, 0
    v_mov_b32 v21, 1
    v_mov_b32 v17, 148992
    v_lshlrev_b32 v24, 4, v1
    v_mov_b32 v27, 0
    s_mov_b32 s46, 6291456
    s_mov_b32 s47, 6291456
    s_waitcnt lgkmcnt(0)
    s_mov_b32 s36, s78
    s_mov_b32 s37, s79
    s_mov_b32 s38, 268435456
    s_mov_b32 s39, 0x00020000
    s_mov_b32 s24, s72
    s_mov_b32 s25, s73
    s_mov_b32 s26, 4194304
    s_mov_b32 s27, 0x00020000
    s_cmp_lg_u32 s44, 8
    s_cbranch_scc1 L_w10
    v_lshlrev_b32 v7, 2, v2
    v_add_u32 v7, 149056, v7
    ds_write_b32 v7, v5
    s_lshl_b32 s50, s45, 15
    s_lshl_b32 s51, s43, 12
    s_add_u32 s50, s50, s51
    s_add_u32 s50, s50, 17825792
    s_add_u32 s51, s50, 16384
    buffer_load_dwordx4 v[32:35], v24, s[36:39], s50 offen offset:0 sc1
    buffer_load_dwordx4 v[32:35], v24, s[36:39], s50 offen offset:1024 sc1
    buffer_load_dwordx4 v[32:35], v24, s[36:39], s50 offen offset:2048 sc1
    buffer_load_dwordx4 v[32:35], v24, s[36:39], s50 offen offset:3072 sc1
    s_waitcnt lgkmcnt(0)
    s_barrier
    buffer_load_dwordx4 v[32:35], v24, s[36:39], s51 offen offset:0 sc1
    buffer_load_dwordx4 v[32:35], v24, s[36:39], s51 offen offset:1024 sc1
    buffer_load_dwordx4 v[32:35], v24, s[36:39], s51 offen offset:2048 sc1
    buffer_load_dwordx4 v[32:35], v24, s[36:39], s51 offen offset:3072 sc1
    v_add_u32 v26, 12288, v24
    v_add_u32 v25, 0x10000, v26
    v_lshrrev_b32 v27, 2, v2
    v_lshlrev_b32 v27, 17, v27
    v_and_b32 v28, 3, v2
    v_lshl_add_u32 v27, v28, 9, v27
    v_lshl_add_u32 v27, v3, 4, v27
    s_lshl_b32 s52, s40, 14
    s_lshr_b32 s53, s43, 1
    s_lshl_b32 s53, s53, 13
    s_add_u32 s52, s52, s53
    s_lshr_b32 s53, s42, 1
    s_lshl_b32 s53, s53, 11
    s_add_u32 s52, s52, s53
    s_and_b32 s53, s42, 1
    s_lshl_b32 s53, s53, 8
    s_add_u32 s52, s52, s53
    s_and_b32 s53, s43, 1
    s_lshl_b32 s53, s53, 7
    s_add_u32 s52, s52, s53
    s_lshl_b32 s53, s40, 14
    s_add_u32 s54, s52, s53
    s_add_u32 s54, s54, 17825792
    s_add_u32 s55, s54, 0x100000
    v_lshrrev_b32 v29, 2, v2
    v_lshl_add_u32 v29, v29, 17, v27
    s_add_u32 s52, s52, 6291456
    s_add_u32 s53, s52, 0x80000
    s_nop 0
    s_mov_b32 s96, 4294967168
    v_mov_b32 v32, 0
    v_mov_b32 v33, 0
    v_mov_b32 v34, 0
    v_mov_b32 v35, 0
    s_lshl_b32 s50, s45, 10
    s_lshl_b32 s51, s43, 8
    s_add_u32 s50, s50, s51
    s_add_u32 s50, s50, 17301504
    v_lshlrev_b32 v28, 4, v2
    s_lshl_b32 s50, s45, 10
    s_add_u32 s50, s50, 17301504
    buffer_load_dwordx4 v[32:35], v24, s[36:39], s50 offen sc1
    s_lshl_b32 s50, s45, 7
    s_add_u32 s50, s50, 17432576
    buffer_load_dword v32, v5, s[36:39], s50 offen sc1
    s_mov_b32 s61, 0
Lsp_42:
    ds_read_b32 v7, v6 offset:8
    s_waitcnt lgkmcnt(0)
    v_readfirstlane_b32 s60, v7
    s_nop 3
    s_cmp_ge_u32 s60, 8
    s_cbranch_scc1 Lspd_43
    s_sleep 1
    s_add_u32 s61, s61, 1
    s_cmp_lt_u32 s61, 400000
    s_cbranch_scc1 Lsp_42
Lspd_43:
    s_waitcnt vmcnt(0)
    ds_read_b128 v[32:35], v26 offset:0
    ds_read_b128 v[36:39], v26 offset:16384
    ds_read_b128 v[40:43], v26 offset:32768
    ds_read_b128 v[44:47], v26 offset:49152
    ds_read_b128 v[48:51], v25 offset:0
    ds_read_b128 v[52:55], v25 offset:16384
    ds_read_b128 v[56:59], v25 offset:32768
    ds_read_b128 v[60:63], v25 offset:49152
    s_waitcnt lgkmcnt(0)
    ds_read_b128 v[64:67], v26 offset:1024
    ds_read_b128 v[68:71], v26 offset:17408
    ds_read_b128 v[72:75], v26 offset:33792
    ds_read_b128 v[76:79], v26 offset:50176
    ds_read_b128 v[80:83], v25 offset:1024
    ds_read_b128 v[84:87], v25 offset:17408
    ds_read_b128 v[88:91], v25 offset:33792
    ds_read_b128 v[92:95], v25 offset:50176
    s_waitcnt lgkmcnt(0)
    ds_read_b128 v[96:99], v26 offset:2048
    ds_read_b128 v[100:103], v26 offset:18432
    ds_read_b128 v[104:107], v26 offset:34816
    ds_read_b128 v[108:111], v26 offset:51200
    ds_read_b128 v[112:115], v25 offset:2048
    ds_read_b128 v[116:119], v25 offset:18432
    ds_read_b128 v[120:123], v25 offset:34816
    ds_read_b128 v[124:127], v25 offset:51200
    s_waitcnt lgkmcnt(0)
    ds_read_b128 v[128:131], v26 offset:3072
    ds_read_b128 v[132:135], v26 offset:19456
    ds_read_b128 v[136:139], v26 offset:35840
    ds_read_b128 v[140:143], v26 offset:52224
    ds_read_b128 v[144:147], v25 offset:3072
    ds_read_b128 v[148:151], v25 offset:19456
    ds_read_b128 v[152:155], v25 offset:35840
    ds_read_b128 v[156:159], v25 offset:52224
    s_waitcnt lgkmcnt(0)
    ds_write_b32 v6, v21 offset:12
    v_pk_add_f32 v[32:33], v[32:33], v[48:49]
    v_pk_add_f32 v[34:35], v[34:35], v[50:51]
    v_pk_add_f32 v[36:37], v[36:37], v[52:53]
    v_pk_add_f32 v[38:39], v[38:39], v[54:55]
    v_pk_add_f32 v[40:41], v[40:41], v[56:57]
    v_pk_add_f32 v[42:43], v[42:43], v[58:59]
    v_pk_add_f32 v[44:45], v[44:45], v[60:61]
    v_pk_add_f32 v[46:47], v[46:47], v[62:63]
    v_pk_add_f32 v[32:33], v[32:33], v[40:41]
    v_pk_add_f32 v[34:35], v[34:35], v[42:43]
    v_pk_add_f32 v[36:37], v[36:37], v[44:45]
    v_pk_add_f32 v[38:39], v[38:39], v[46:47]
    v_pk_add_f32 v[32:33], v[32:33], v[36:37]
    v_pk_add_f32 v[34:35], v[34:35], v[38:39]
    v_add_u32 v32, 64, v32
    v_and_b32 v32, s96, v32
    v_add_u32 v33, 64, v33
    v_and_b32 v33, s96, v33
    v_add_u32 v34, 64, v34
    v_and_b32 v34, s96, v34
    v_add_u32 v35, 64, v35
    v_and_b32 v35, s96, v35
    v_pk_add_f32 v[64:65], v[64:65], v[80:81]
    v_pk_add_f32 v[66:67], v[66:67], v[82:83]
    v_pk_add_f32 v[68:69], v[68:69], v[84:85]
    v_pk_add_f32 v[70:71], v[70:71], v[86:87]
    v_pk_add_f32 v[72:73], v[72:73], v[88:89]
    v_pk_add_f32 v[74:75], v[74:75], v[90:91]
    v_pk_add_f32 v[76:77], v[76:77], v[92:93]
    v_pk_add_f32 v[78:79], v[78:79], v[94:95]
    v_pk_add_f32 v[64:65], v[64:65], v[72:73]
    v_pk_add_f32 v[66:67], v[66:67], v[74:75]
    v_pk_add_f32 v[68:69], v[68:69], v[76:77]
    v_pk_add_f32 v[70:71], v[70:71], v[78:79]
    v_pk_add_f32 v[64:65], v[64:65], v[68:69]
    v_pk_add_f32 v[66:67], v[66:67], v[70:71]
    v_add_u32 v64, 64, v64
    v_and_b32 v64, s96, v64
    v_add_u32 v65, 64, v65
    v_and_b32 v65, s96, v65
    v_add_u32 v66, 64, v66
    v_and_b32 v66, s96, v66
    v_add_u32 v67, 64, v67
    v_and_b32 v67, s96, v67
    v_pk_add_f32 v[96:97], v[96:97], v[112:113]
    v_pk_add_f32 v[98:99], v[98:99], v[114:115]
    v_pk_add_f32 v[100:101], v[100:101], v[116:117]
    v_pk_add_f32 v[102:103], v[102:103], v[118:119]
    v_pk_add_f32 v[104:105], v[104:105], v[120:121]
    v_pk_add_f32 v[106:107], v[106:107], v[122:123]
    v_pk_add_f32 v[108:109], v[108:109], v[124:125]
    v_pk_add_f32 v[110:111], v[110:111], v[126:127]
    v_pk_add_f32 v[96:97], v[96:97], v[104:105]
    v_pk_add_f32 v[98:99], v[98:99], v[106:107]
    v_pk_add_f32 v[100:101], v[100:101], v[108:109]
    v_pk_add_f32 v[102:103], v[102:103], v[110:111]
    v_pk_add_f32 v[96:97], v[96:97], v[100:101]
    v_pk_add_f32 v[98:99], v[98:99], v[102:103]
    v_add_u32 v96, 64, v96
    v_and_b32 v96, s96, v96
    v_add_u32 v97, 64, v97
    v_and_b32 v97, s96, v97
    v_add_u32 v98, 64, v98
    v_and_b32 v98, s96, v98
    v_add_u32 v99, 64, v99
    v_and_b32 v99, s96, v99
    v_pk_add_f32 v[128:129], v[128:129], v[144:145]
    v_pk_add_f32 v[130:131], v[130:131], v[146:147]
    v_pk_add_f32 v[132:133], v[132:133], v[148:149]
    v_pk_add_f32 v[134:135], v[134:135], v[150:151]
    v_pk_add_f32 v[136:137], v[136:137], v[152:153]
    v_pk_add_f32 v[138:139], v[138:139], v[154:155]
    v_pk_add_f32 v[140:141], v[140:141], v[156:157]
    v_pk_add_f32 v[142:143], v[142:143], v[158:159]
    v_pk_add_f32 v[128:129], v[128:129], v[136:137]
    v_pk_add_f32 v[130:131], v[130:131], v[138:139]
    v_pk_add_f32 v[132:133], v[132:133], v[140:141]
    v_pk_add_f32 v[134:135], v[134:135], v[142:143]
    v_pk_add_f32 v[128:129], v[128:129], v[132:133]
    v_pk_add_f32 v[130:131], v[130:131], v[134:135]
    v_add_u32 v128, 64, v128
    v_and_b32 v128, s96, v128
    v_add_u32 v129, 64, v129
    v_and_b32 v129, s96, v129
    v_add_u32 v130, 64, v130
    v_and_b32 v130, s96, v130
    v_add_u32 v131, 64, v131
    v_and_b32 v131, s96, v131
    s_mov_b32 s61, 0
Lsp_44:
    ds_read_b32 v7, v6 offset:28
    s_waitcnt lgkmcnt(0)
    v_readfirstlane_b32 s60, v7
    s_nop 3
    s_cmp_ge_u32 s60, 1
    s_cbranch_scc1 Lspd_45
    s_sleep 1
    s_add_u32 s61, s61, 1
    s_cmp_lt_u32 s61, 400000
    s_cbranch_scc1 Lsp_44
Lspd_45:
    ds_read_b64 v[10:11], v17
    s_waitcnt lgkmcnt(0)
    v_readfirstlane_b32 s98, v10
    v_readfirstlane_b32 s99, v11
    s_nop 3
    s_bfe_u32 s56, s98, 458752
    s_bfe_u32 s57, s98, 458759
    s_bfe_u32 s58, s98, 458766
    s_bfe_u32 s59, s98, 458773
    s_xor_b32 s56, s56, 1
    s_getreg_b32 s51, hwreg(HW_REG_XCC_ID)
    s_and_b32 s51, s51, 15
    s_add_u32 s51, s51, 1
    s_xor_b32 s51, s51, s57
    v_or_b32 v8, s56, v32
    v_or_b32 v32, s56, v32
    v_or_b32 v9, s57, v33
    v_or_b32 v33, s51, v33
    v_or_b32 v10, s58, v34
    v_or_b32 v34, s58, v34
    v_or_b32 v11, s59, v35
    v_or_b32 v35, s59, v35
    v_or_b32 v12, s56, v64
    v_or_b32 v64, s56, v64
    v_or_b32 v13, s57, v65
    v_or_b32 v65, s51, v65
    v_or_b32 v14, s58, v66
    v_or_b32 v66, s58, v66
    v_or_b32 v15, s59, v67
    v_or_b32 v67, s59, v67
    v_or_b32 v16, s56, v96
    v_or_b32 v96, s56, v96
    v_or_b32 v17, s57, v97
    v_or_b32 v97, s51, v97
    v_or_b32 v18, s58, v98
    v_or_b32 v98, s58, v98
    v_or_b32 v19, s59, v99
    v_or_b32 v99, s59, v99
    v_or_b32 v20, s56, v128
    v_or_b32 v128, s56, v128
    v_or_b32 v21, s57, v129
    v_or_b32 v129, s51, v129
    v_or_b32 v22, s58, v130
    v_or_b32 v130, s58, v130
    v_or_b32 v23, s59, v131
    v_or_b32 v131, s59, v131
    buffer_store_dwordx4 v[32:35], v29, s[36:39], s54 offen offset:0
    buffer_store_dwordx4 v[64:67], v29, s[36:39], s55 offen offset:0
    buffer_store_dwordx4 v[96:99], v29, s[36:39], s54 offen offset:64
    buffer_store_dwordx4 v[128:131], v29, s[36:39], s55 offen offset:64
    s_mov_b32 s46, s52
    s_mov_b32 s47, s53
    s_nop 1
    s_branch L_wo
L_w10:
    s_mov_b32 s32, s76
    s_mov_b32 s33, s77
    s_mov_b32 s34, 256
    s_mov_b32 s35, 0x00020000
    s_lshl_b64 s[98:99], s[98:99], 1
    s_or_b32 s98, s98, 1
    s_or_b32 s99, s99, 0x80000000
    s_cmp_lg_u32 s2, 0
    s_cbranch_scc1 L_n0
    v_mov_b32 v22, s98
    v_mov_b32 v23, s99
    s_mov_b64 exec, 1
    buffer_store_dwordx2 v[22:23], v5, s[32:35], 0 offen sc0 sc1
    s_mov_b64 exec, -1
    s_barrier
    s_branch L_n1
L_n0:
    buffer_load_dwordx2 v[22:23], v5, s[32:35], 0 offen sc1
    s_barrier
    s_mov_b32 s61, 0
L_auxn:
    s_waitcnt vmcnt(0)
    v_readfirstlane_b32 s98, v22
    v_readfirstlane_b32 s99, v23
    s_nop 3
    s_cmp_lt_i32 s99, 0
    s_cbranch_scc1 L_n1
    buffer_load_dwordx2 v[22:23], v5, s[32:35], 0 offen sc1
    s_add_u32 s61, s61, 1
    s_cmp_lt_u32 s61, 20000
    s_cbranch_scc1 L_auxn
L_n1:
    v_mov_b32 v22, s98
    v_mov_b32 v23, s99
    ds_write_b64 v17, v[22:23]
    s_waitcnt lgkmcnt(0)
    ds_write_b32 v6, v21 offset:28
    s_lshl_b32 s50, s45, 14
    s_add_u32 s50, s50, 6291456
    s_lshl_b32 s51, s45, 15
    s_add_u32 s51, s51, 17825792
    v_lshlrev_b32 v16, 3, v1
    v_add_u32 v16, 151552, v16
    v_lshrrev_b32 v18, 5, v1
    v_lshlrev_b32 v18, 13, v18
    v_bfe_u32 v19, v1, 3, 2
    v_lshl_add_u32 v18, v19, 11, v18
    v_and_b32 v19, 7, v1
    v_lshl_add_u32 v18, v19, 6, v18
    s_bfe_u32 s56, s98, 458752
    s_bfe_u32 s57, s98, 458759
    s_bfe_u32 s58, s98, 458766
    s_bfe_u32 s59, s98, 458773
    s_xor_b32 s56, s56, 1
    s_getreg_b32 s53, hwreg(HW_REG_XCC_ID)
    s_and_b32 s53, s53, 15
    s_add_u32 s53, s53, 1
    s_xor_b32 s53, s53, s57
    s_mov_b32 s52, s57
    s_mov_b32 s61, 0
Lsp_46:
    ds_read_b32 v7, v6 offset:12
    s_waitcnt lgkmcnt(0)
    v_readfirstlane_b32 s60, v7
    s_nop 3
    s_cmp_ge_u32 s60, 1
    s_cbranch_scc1 Lspd_47
    s_sleep 1
    s_add_u32 s61, s61, 1
    s_cmp_lt_u32 s61, 400000
    s_cbranch_scc1 Lsp_46
Lspd_47:
    s_mov_b32 s61, 0
Lsp_48:
    ds_read_b64 v[28:29], v6 offset:0
    s_waitcnt lgkmcnt(0)
    v_min_u32 v28, v28, v29
    s_nop 0
    v_readfirstlane_b32 s60, v28
    s_nop 3
    s_cmp_ge_u32 s60, 2
    s_cbranch_scc1 Lspd_49
    s_sleep 2
    s_add_u32 s61, s61, 1
    s_cmp_lt_u32 s61, 400000
    s_cbranch_scc1 Lsp_48
Lspd_49:
    s_mov_b32 s61, 0
L_aux4:
    s_and_b32 s54, s61, 15
    s_cmp_eq_u32 s54, 15
    s_cselect_b32 s54, s50, s51
    s_cselect_b32 s57, s52, s53
    s_cselect_b32 s49, 1, 2
    s_add_u32 s55, s54, 0
    buffer_load_dwordx4 v[32:35], v24, s[36:39], s55 offen offset:0 sc1
    buffer_load_dwordx4 v[36:39], v24, s[36:39], s55 offen offset:1024 sc1
    buffer_load_dwordx4 v[40:43], v24, s[36:39], s55 offen offset:2048 sc1
    buffer_load_dwordx4 v[44:47], v24, s[36:39], s55 offen offset:3072 sc1
    s_add_u32 s55, s54, 4096
    buffer_load_dwordx4 v[48:51], v24, s[36:39], s55 offen offset:0 sc1
    buffer_load_dwordx4 v[52:55], v24, s[36:39], s55 offen offset:1024 sc1
    buffer_load_dwordx4 v[56:59], v24, s[36:39], s55 offen offset:2048 sc1
    buffer_load_dwordx4 v[60:63], v24, s[36:39], s55 offen offset:3072 sc1
    s_add_u32 s55, s54, 8192
    buffer_load_dwordx4 v[64:67], v24, s[36:39], s55 offen offset:0 sc1
    buffer_load_dwordx4 v[68:71], v24, s[36:39], s55 offen offset:1024 sc1
    buffer_load_dwordx4 v[72:75], v24, s[36:39], s55 offen offset:2048 sc1
    buffer_load_dwordx4 v[76:79], v24, s[36:39], s55 offen offset:3072 sc1
    s_add_u32 s55, s54, 12288
    buffer_load_dwordx4 v[80:83], v24, s[36:39], s55 offen offset:0 sc1
    buffer_load_dwordx4 v[84:87], v24, s[36:39], s55 offen offset:1024 sc1
    buffer_load_dwordx4 v[88:91], v24, s[36:39], s55 offen offset:2048 sc1
    buffer_load_dwordx4 v[92:95], v24, s[36:39], s55 offen offset:3072 sc1
    s_waitcnt vmcnt(0)
    v_xor_b32 v32, s56, v32
    v_xor_b32 v33, s57, v33
    v_xor_b32 v34, s58, v34
    v_xor_b32 v35, s59, v35
    v_xor_b32 v36, s56, v36
    v_xor_b32 v37, s57, v37
    v_xor_b32 v38, s58, v38
    v_xor_b32 v39, s59, v39
    v_xor_b32 v40, s56, v40
    v_xor_b32 v41, s57, v41
    v_xor_b32 v42, s58, v42
    v_xor_b32 v43, s59, v43
    v_xor_b32 v44, s56, v44
    v_xor_b32 v45, s57, v45
    v_xor_b32 v46, s58, v46
    v_xor_b32 v47, s59, v47
    v_xor_b32 v48, s56, v48
    v_xor_b32 v49, s57, v49
    v_xor_b32 v50, s58, v50
    v_xor_b32 v51, s59, v51
    v_xor_b32 v52, s56, v52
    v_xor_b32 v53, s57, v53
    v_xor_b32 v54, s58, v54
    v_xor_b32 v55, s59, v55
    v_xor_b32 v56, s56, v56
    v_xor_b32 v57, s57, v57
    v_xor_b32 v58, s58, v58
    v_xor_b32 v59, s59, v59
    v_xor_b32 v60, s56, v60
    v_xor_b32 v61, s57, v61
    v_xor_b32 v62, s58, v62
    v_xor_b32 v63, s59, v63
    v_xor_b32 v64, s56, v64
    v_xor_b32 v65, s57, v65
    v_xor_b32 v66, s58, v66
    v_xor_b32 v67, s59, v67
    v_xor_b32 v68, s56, v68
    v_xor_b32 v69, s57, v69
    v_xor_b32 v70, s58, v70
    v_xor_b32 v71, s59, v71
    v_xor_b32 v72, s56, v72
    v_xor_b32 v73, s57, v73
    v_xor_b32 v74, s58, v74
    v_xor_b32 v75, s59, v75
    v_xor_b32 v76, s56, v76
    v_xor_b32 v77, s57, v77
    v_xor_b32 v78, s58, v78
    v_xor_b32 v79, s59, v79
    v_xor_b32 v80, s56, v80
    v_xor_b32 v81, s57, v81
    v_xor_b32 v82, s58, v82
    v_xor_b32 v83, s59, v83
    v_xor_b32 v84, s56, v84
    v_xor_b32 v85, s57, v85
    v_xor_b32 v86, s58, v86
    v_xor_b32 v87, s59, v87
    v_xor_b32 v88, s56, v88
    v_xor_b32 v89, s57, v89
    v_xor_b32 v90, s58, v90
    v_xor_b32 v91, s59, v91
    v_xor_b32 v92, s56, v92
    v_xor_b32 v93, s57, v93
    v_xor_b32 v94, s58, v94
    v_xor_b32 v95, s59, v95
    v_or3_b32 v7, v32, v33, v34
    v_or3_b32 v7, v7, v35, v36
    v_or3_b32 v7, v7, v37, v38
    v_or3_b32 v7, v7, v39, v40
    v_or3_b32 v7, v7, v41, v42
    v_or3_b32 v7, v7, v43, v44
    v_or3_b32 v7, v7, v45, v46
    v_or3_b32 v7, v7, v47, v48
    v_or3_b32 v7, v7, v49, v50
    v_or3_b32 v7, v7, v51, v52
    v_or3_b32 v7, v7, v53, v54
    v_or3_b32 v7, v7, v55, v56
    v_or3_b32 v7, v7, v57, v58
    v_or3_b32 v7, v7, v59, v60
    v_or3_b32 v7, v7, v61, v62
    v_or3_b32 v7, v7, v63, v64
    v_or3_b32 v7, v7, v65, v66
    v_or3_b32 v7, v7, v67, v68
    v_or3_b32 v7, v7, v69, v70
    v_or3_b32 v7, v7, v71, v72
    v_or3_b32 v7, v7, v73, v74
    v_or3_b32 v7, v7, v75, v76
    v_or3_b32 v7, v7, v77, v78
    v_or3_b32 v7, v7, v79, v80
    v_or3_b32 v7, v7, v81, v82
    v_or3_b32 v7, v7, v83, v84
    v_or3_b32 v7, v7, v85, v86
    v_or3_b32 v7, v7, v87, v88
    v_or3_b32 v7, v7, v89, v90
    v_or3_b32 v7, v7, v91, v92
    v_or3_b32 v7, v7, v93, v94
    v_or_b32 v7, v7, v95
    v_and_b32 v7, 127, v7
    v_cmp_eq_u32 vcc, 0, v7
    s_nop 3
    s_cmp_eq_u64 vcc, -1
    s_cbranch_scc1 L_aux5
    s_add_u32 s61, s61, 1
    s_cmp_lt_u32 s61, 20000
    s_cbranch_scc1 L_aux4
L_aux5:
    v_pk_add_f32 v[32:33], v[32:33], v[64:65]
    v_pk_add_f32 v[34:35], v[34:35], v[66:67]
    v_cvt_pk_bf16_f32 v32, v32, v33
    v_cvt_pk_bf16_f32 v33, v34, v35
    ds_write_b64 v16, v[32:33] offset:0
    v_pk_add_f32 v[36:37], v[36:37], v[68:69]
    v_pk_add_f32 v[38:39], v[38:39], v[70:71]
    v_cvt_pk_bf16_f32 v36, v36, v37
    v_cvt_pk_bf16_f32 v37, v38, v39
    ds_write_b64 v16, v[36:37] offset:512
    v_pk_add_f32 v[40:41], v[40:41], v[72:73]
    v_pk_add_f32 v[42:43], v[42:43], v[74:75]
    v_cvt_pk_bf16_f32 v40, v40, v41
    v_cvt_pk_bf16_f32 v41, v42, v43
    ds_write_b64 v16, v[40:41] offset:1024
    v_pk_add_f32 v[44:45], v[44:45], v[76:77]
    v_pk_add_f32 v[46:47], v[46:47], v[78:79]
    v_cvt_pk_bf16_f32 v44, v44, v45
    v_cvt_pk_bf16_f32 v45, v46, v47
    ds_write_b64 v16, v[44:45] offset:1536
    v_pk_add_f32 v[48:49], v[48:49], v[80:81]
    v_pk_add_f32 v[50:51], v[50:51], v[82:83]
    v_cvt_pk_bf16_f32 v48, v48, v49
    v_cvt_pk_bf16_f32 v49, v50, v51
    ds_write_b64 v16, v[48:49] offset:2048
    v_pk_add_f32 v[52:53], v[52:53], v[84:85]
    v_pk_add_f32 v[54:55], v[54:55], v[86:87]
    v_cvt_pk_bf16_f32 v52, v52, v53
    v_cvt_pk_bf16_f32 v53, v54, v55
    ds_write_b64 v16, v[52:53] offset:2560
    v_pk_add_f32 v[56:57], v[56:57], v[88:89]
    v_pk_add_f32 v[58:59], v[58:59], v[90:91]
    v_cvt_pk_bf16_f32 v56, v56, v57
    v_cvt_pk_bf16_f32 v57, v58, v59
    ds_write_b64 v16, v[56:57] offset:3072
    v_pk_add_f32 v[60:61], v[60:61], v[92:93]
    v_pk_add_f32 v[62:63], v[62:63], v[94:95]
    v_cvt_pk_bf16_f32 v60, v60, v61
    v_cvt_pk_bf16_f32 v61, v62, v63
    ds_write_b64 v16, v[60:61] offset:3584
    v_mov_b32 v21, s49
    s_waitcnt lgkmcnt(0)
    ds_write_b32 v6, v21 offset:16
    s_waitcnt lgkmcnt(0)
    s_lshl_b32 s46, s45, 7
    s_add_u32 s46, s46, 655360
    s_lshl_b32 s50, s43, 4
    s_add_u32 s50, s50, s46
    s_add_u32 s51, s50, s3
    s_mov_b64 exec, 1
    buffer_store_dwordx2 v[22:23], v5, s[36:39], s51 offen
    s_cmp_eq_u32 s49, 2
    s_cbranch_scc1 L_tk1
    buffer_store_dwordx2 v[22:23], v5, s[36:39], s50 offen sc1
L_tk1:
    s_mov_b64 exec, -1
L_wo:
    s_setprio 1
    s_add_u32 s50, s97, 0
    buffer_load_dwordx2 v[56:57], v4, s[24:27], s50 offen offset:0
    s_add_u32 s50, s97, 0
    buffer_load_dwordx2 v[58:59], v4, s[24:27], s50 offen offset:1024
    s_add_u32 s50, s97, 0
    buffer_load_dwordx2 v[60:61], v4, s[24:27], s50 offen offset:2048
    s_add_u32 s50, s97, 0
    buffer_load_dwordx2 v[62:63], v4, s[24:27], s50 offen offset:3072
    s_add_u32 s50, s97, 4096
    buffer_load_dwordx2 v[64:65], v4, s[24:27], s50 offen offset:0
    s_add_u32 s50, s97, 4096
    buffer_load_dwordx2 v[66:67], v4, s[24:27], s50 offen offset:1024
    s_add_u32 s50, s97, 4096
    buffer_load_dwordx2 v[68:69], v4, s[24:27], s50 offen offset:2048
    s_add_u32 s50, s97, 4096
    buffer_load_dwordx2 v[70:71], v4, s[24:27], s50 offen offset:3072
    s_waitcnt vmcnt(7)
    s_add_u32 s50, s97, 32768
    buffer_load_dwordx2 v[72:73], v4, s[24:27], s50 offen offset:0
    s_waitcnt vmcnt(7)
    s_add_u32 s50, s97, 32768
    buffer_load_dwordx2 v[74:75], v4, s[24:27], s50 offen offset:1024
    s_waitcnt vmcnt(7)
    s_add_u32 s50, s97, 32768
    buffer_load_dwordx2 v[76:77], v4, s[24:27], s50 offen offset:2048
    s_waitcnt vmcnt(7)
    s_add_u32 s50, s97, 32768
    buffer_load_dwordx2 v[78:79], v4, s[24:27], s50 offen offset:3072
    s_waitcnt vmcnt(7)
    s_add_u32 s50, s97, 36864
    buffer_load_dwordx2 v[80:81], v4, s[24:27], s50 offen offset:0
    s_waitcnt vmcnt(7)
    s_add_u32 s50, s97, 36864
    buffer_load_dwordx2 v[82:83], v4, s[24:27], s50 offen offset:1024
    s_waitcnt vmcnt(7)
    s_add_u32 s50, s97, 36864
    buffer_load_dwordx2 v[84:85], v4, s[24:27], s50 offen offset:2048
    s_waitcnt vmcnt(7)
    s_add_u32 s50, s97, 36864
    buffer_load_dwordx2 v[86:87], v4, s[24:27], s50 offen offset:3072
    s_waitcnt vmcnt(7)
    s_add_u32 s50, s97, 65536
    buffer_load_dwordx2 v[88:89], v4, s[24:27], s50 offen offset:0
    s_waitcnt vmcnt(7)
    s_add_u32 s50, s97, 65536
    buffer_load_dwordx2 v[90:91], v4, s[24:27], s50 offen offset:1024
    s_waitcnt vmcnt(7)
    s_add_u32 s50, s97, 65536
    buffer_load_dwordx2 v[92:93], v4, s[24:27], s50 offen offset:2048
    s_waitcnt vmcnt(7)
    s_add_u32 s50, s97, 65536
    buffer_load_dwordx2 v[94:95], v4, s[24:27], s50 offen offset:3072
    s_waitcnt vmcnt(7)
    s_add_u32 s50, s97, 69632
    buffer_load_dwordx2 v[96:97], v4, s[24:27], s50 offen offset:0
    s_waitcnt vmcnt(7)
    s_add_u32 s50, s97, 69632
    buffer_load_dwordx2 v[98:99], v4, s[24:27], s50 offen offset:1024
    s_waitcnt vmcnt(7)
    s_add_u32 s50, s97, 69632
    buffer_load_dwordx2 v[100:101], v4, s[24:27], s50 offen offset:2048
    s_waitcnt vmcnt(7)
    s_add_u32 s50, s97, 69632
    buffer_load_dwordx2 v[102:103], v4, s[24:27], s50 offen offset:3072
    s_waitcnt vmcnt(7)
    s_add_u32 s50, s97, 98304
    buffer_load_dwordx2 v[104:105], v4, s[24:27], s50 offen offset:0
    s_waitcnt vmcnt(7)
    s_add_u32 s50, s97, 98304
    buffer_load_dwordx2 v[106:107], v4, s[24:27], s50 offen offset:1024
    s_waitcnt vmcnt(7)
    s_add_u32 s50, s97, 98304
    buffer_load_dwordx2 v[108:109], v4, s[24:27], s50 offen offset:2048
    s_waitcnt vmcnt(7)
    s_add_u32 s50, s97, 98304
    buffer_load_dwordx2 v[110:111], v4, s[24:27], s50 offen offset:3072
    s_waitcnt vmcnt(7)
    s_add_u32 s50, s97, 102400
    buffer_load_dwordx2 v[112:113], v4, s[24:27], s50 offen offset:0
    s_waitcnt vmcnt(7)
    s_add_u32 s50, s97, 102400
    buffer_load_dwordx2 v[114:115], v4, s[24:27], s50 offen offset:1024
    s_waitcnt vmcnt(7)
    s_add_u32 s50, s97, 102400
    buffer_load_dwordx2 v[116:117], v4, s[24:27], s50 offen offset:2048
    s_waitcnt vmcnt(7)
    s_add_u32 s50, s97, 102400
    buffer_load_dwordx2 v[118:119], v4, s[24:27], s50 offen offset:3072
    s_cmp_lg_u32 s44, 8
    s_cbranch_scc1 L_tr
    s_setprio 3
    s_mov_b32 s61, 0
L_dq:
    ds_read_b64 v[28:29], v6 offset:0
    ds_read_b32 v30, v6 offset:16
    s_waitcnt lgkmcnt(0)
    v_min_u32 v28, v28, v29
    v_readfirstlane_b32 s60, v30
    v_readfirstlane_b32 s50, v28
    s_nop 3
    s_cmp_eq_u32 s60, 2
    s_cbranch_scc1 L_dq2
    s_cmp_eq_u32 s60, 1
    s_cbranch_scc1 L_dq1
    s_cmp_ge_u32 s50, 8
    s_cbranch_scc1 L_dq1
    s_sleep 2
    s_add_u32 s61, s61, 1
    s_cmp_lt_u32 s61, 400000
    s_cbranch_scc1 L_dq
L_dq1:
    buffer_store_dwordx4 v[8:11], v27, s[36:39], s46 offen offset:0 sc1
    buffer_store_dwordx4 v[12:15], v27, s[36:39], s47 offen offset:0 sc1
    buffer_store_dwordx4 v[16:19], v27, s[36:39], s46 offen offset:64 sc1
    buffer_store_dwordx4 v[20:23], v27, s[36:39], s47 offen offset:64 sc1
    s_waitcnt vmcnt(0)
L_dq2:
    s_mov_b32 s61, 0
Lsp_50:
    ds_read_b32 v7, v6 offset:16
    s_waitcnt lgkmcnt(0)
    v_readfirstlane_b32 s60, v7
    s_nop 3
    s_cmp_ge_u32 s60, 1
    s_cbranch_scc1 Lspd_51
    s_sleep 1
    s_add_u32 s61, s61, 1
    s_cmp_lt_u32 s61, 400000
    s_cbranch_scc1 Lsp_50
Lspd_51:
    s_lshl_b32 s46, s45, 7
    s_add_u32 s46, s46, 655360
    v_lshlrev_b32 v28, 4, v3
    v_mov_b32 v29, 1
    s_mov_b32 s61, 0
L_tk2:
    s_and_b32 s55, s61, 15
    s_cmp_eq_u32 s55, 15
    s_cselect_b32 s55, 0, s3
    s_add_u32 s55, s55, s46
    buffer_load_dwordx2 v[30:31], v28, s[36:39], s55 offen sc1
    s_waitcnt vmcnt(0)
    v_xor_b32 v30, s98, v30
    v_xor_b32 v31, s99, v31
    v_or_b32 v30, v30, v31
    v_cmp_eq_u32 vcc, 0, v30
    s_nop 3
    s_cmp_eq_u64 vcc, -1
    s_cbranch_scc1 L_tk3
    s_add_u32 s61, s61, 1
    s_cmp_lt_u32 s61, 20000
    s_cbranch_scc1 L_tk2
L_tk3:
    ds_write_b32 v6, v29 offset:60
    s_waitcnt lgkmcnt(0)
    v_lshlrev_b32 v29, 4, v2
    s_andn2_b32 s50, s45, 8
    s_lshl_b32 s50, s50, 10
    s_add_u32 s50, s50, 524288
    v_lshl_add_u32 v30, v3, 8, v29
    v_lshlrev_b32 v31, 2, v1
    v_add_u32 v31, 148480, v31
    v_mov_b32 v32, 1
    s_mov_b32 s61, 0
Lsp_52:
    ds_read_b32 v7, v6 offset:24
    s_waitcnt lgkmcnt(0)
    v_readfirstlane_b32 s60, v7
    s_nop 3
    s_cmp_ge_u32 s60, 8
    s_cbranch_scc1 Lspd_53
    s_sleep 1
    s_add_u32 s61, s61, 1
    s_cmp_lt_u32 s61, 400000
    s_cbranch_scc1 Lsp_52
Lspd_53:
    s_mov_b32 s61, 0
L_st6:
    s_and_b32 s55, s61, 15
    s_cmp_eq_u32 s55, 15
    s_cselect_b32 s55, 0, s3
    s_add_u32 s55, s55, s50
    s_add_u32 s54, s55, 8192
    buffer_load_dwordx4 v[8:11], v30, s[36:39], s55 offen sc1
    buffer_load_dwordx4 v[16:19], v30, s[36:39], s54 offen sc1
    s_waitcnt vmcnt(0)
    v_xor_b32 v10, s98, v10
    v_xor_b32 v11, s99, v11
    v_xor_b32 v18, s98, v18
    v_xor_b32 v19, s99, v19
    v_or3_b32 v10, v10, v11, v18
    v_or_b32 v10, v10, v19
    v_cmp_eq_u32 vcc, 0, v10
    s_nop 3
    s_cmp_eq_u64 vcc, -1
    s_cbranch_scc1 L_st7
    s_add_u32 s61, s61, 1
    s_cmp_lt_u32 s61, 20000
    s_cbranch_scc1 L_st6
L_st7:
    v_mov_b32 v12, v8
    v_mov_b32 v13, v12
    s_nop 1
    v_permlane32_swap_b32 v12, v13
    s_nop 0
    v_max_f32 v12, v12, v13
    v_mov_b32 v13, v12
    s_nop 1
    v_permlane16_swap_b32 v12, v13
    s_nop 0
    v_max_f32 v12, v12, v13
    v_sub_f32 v8, v8, v12
    v_exp_f32 v13, v8
    s_nop 0
    v_mul_f32 v8, v13, v9
    v_mov_b32 v9, v8
    s_nop 1
    v_permlane32_swap_b32 v8, v9
    s_nop 0
    v_add_f32 v8, v8, v9
    v_mov_b32 v9, v8
    s_nop 1
    v_permlane16_swap_b32 v8, v9
    s_nop 0
    v_add_f32 v8, v8, v9
    v_rcp_f32 v8, v8
    s_nop 0
    v_mul_f32 v13, v13, v8
    ds_write_b32 v31, v13 offset:0
    v_mov_b32 v20, v16
    v_mov_b32 v21, v20
    s_nop 1
    v_permlane32_swap_b32 v20, v21
    s_nop 0
    v_max_f32 v20, v20, v21
    v_mov_b32 v21, v20
    s_nop 1
    v_permlane16_swap_b32 v20, v21
    s_nop 0
    v_max_f32 v20, v20, v21
    v_sub_f32 v16, v16, v20
    v_exp_f32 v21, v16
    s_nop 0
    v_mul_f32 v16, v21, v17
    v_mov_b32 v17, v16
    s_nop 1
    v_permlane32_swap_b32 v16, v17
    s_nop 0
    v_add_f32 v16, v16, v17
    v_mov_b32 v17, v16
    s_nop 1
    v_permlane16_swap_b32 v16, v17
    s_nop 0
    v_add_f32 v16, v16, v17
    v_rcp_f32 v16, v16
    s_nop 0
    v_mul_f32 v21, v21, v16
    ds_write_b32 v31, v21 offset:256
    s_waitcnt lgkmcnt(0)
    ds_write_b32 v6, v32 offset:32
    s_waitcnt lgkmcnt(0)
L_tr:
    s_setprio 0
    s_waitcnt vmcnt(0)
L_tr2:
    s_mov_b32 s52, 0x05040100
    s_mov_b32 s53, 0x07060302
    v_perm_b32 v40, v58, v56, s52
    v_perm_b32 v41, v62, v60, s52
    v_perm_b32 v42, v66, v64, s52
    v_perm_b32 v43, v70, v68, s52
    v_perm_b32 v44, v58, v56, s53
    v_perm_b32 v45, v62, v60, s53
    v_perm_b32 v46, v66, v64, s53
    v_perm_b32 v47, v70, v68, s53
    v_perm_b32 v48, v59, v57, s52
    v_perm_b32 v49, v63, v61, s52
    v_perm_b32 v50, v67, v65, s52
    v_perm_b32 v51, v71, v69, s52
    v_perm_b32 v52, v59, v57, s53
    v_perm_b32 v53, v63, v61, s53
    v_perm_b32 v54, v67, v65, s53
    v_perm_b32 v55, v71, v69, s53
    v_perm_b32 v56, v74, v72, s52
    v_perm_b32 v57, v78, v76, s52
    v_perm_b32 v58, v82, v80, s52
    v_perm_b32 v59, v86, v84, s52
    v_perm_b32 v60, v74, v72, s53
    v_perm_b32 v61, v78, v76, s53
    v_perm_b32 v62, v82, v80, s53
    v_perm_b32 v63, v86, v84, s53
    v_perm_b32 v64, v75, v73, s52
    v_perm_b32 v65, v79, v77, s52
    v_perm_b32 v66, v83, v81, s52
    v_perm_b32 v67, v87, v85, s52
    v_perm_b32 v68, v75, v73, s53
    v_perm_b32 v69, v79, v77, s53
    v_perm_b32 v70, v83, v81, s53
    v_perm_b32 v71, v87, v85, s53
    v_perm_b32 v72, v90, v88, s52
    v_perm_b32 v73, v94, v92, s52
    v_perm_b32 v74, v98, v96, s52
    v_perm_b32 v75, v102, v100, s52
    v_perm_b32 v76, v90, v88, s53
    v_perm_b32 v77, v94, v92, s53
    v_perm_b32 v78, v98, v96, s53
    v_perm_b32 v79, v102, v100, s53
    v_perm_b32 v80, v91, v89, s52
    v_perm_b32 v81, v95, v93, s52
    v_perm_b32 v82, v99, v97, s52
    v_perm_b32 v83, v103, v101, s52
    v_perm_b32 v84, v91, v89, s53
    v_perm_b32 v85, v95, v93, s53
    v_perm_b32 v86, v99, v97, s53
    v_perm_b32 v87, v103, v101, s53
    v_perm_b32 v88, v106, v104, s52
    v_perm_b32 v89, v110, v108, s52
    v_perm_b32 v90, v114, v112, s52
    v_perm_b32 v91, v118, v116, s52
    v_perm_b32 v92, v106, v104, s53
    v_perm_b32 v93, v110, v108, s53
    v_perm_b32 v94, v114, v112, s53
    v_perm_b32 v95, v118, v116, s53
    v_perm_b32 v96, v107, v105, s52
    v_perm_b32 v97, v111, v109, s52
    v_perm_b32 v98, v115, v113, s52
    v_perm_b32 v99, v119, v117, s52
    v_perm_b32 v100, v107, v105, s53
    v_perm_b32 v101, v111, v109, s53
    v_perm_b32 v102, v115, v113, s53
    v_perm_b32 v103, v119, v117, s53
    s_mov_b32 s61, 0
Lsp_54:
    ds_read_b32 v120, v6 offset:28
    s_waitcnt lgkmcnt(0)
    v_readfirstlane_b32 s60, v120
    s_nop 3
    s_cmp_ge_u32 s60, 1
    s_cbranch_scc1 Lspd_55
    s_sleep 1
    s_add_u32 s61, s61, 1
    s_cmp_lt_u32 s61, 400000
    s_cbranch_scc1 Lsp_54
Lspd_55:
    v_mov_b32 v122, 148992
    ds_read_b64 v[120:121], v122
    v_and_b32 v4, 7, v2
    v_lshlrev_b32 v4, 8, v4
    v_lshl_add_u32 v4, v3, 4, v4
    v_add_u32 v4, 149504, v4
    v_lshrrev_b32 v123, 2, v2
    v_lshlrev_b32 v123, 13, v123
    v_and_b32 v0, 3, v2
    v_lshl_add_u32 v123, v0, 5, v123
    v_lshrrev_b32 v0, 1, v3
    v_lshl_add_u32 v123, v0, 4, v123
    v_and_b32 v0, 1, v3
    v_lshl_add_u32 v123, v0, 18, v123
    s_andn2_b32 s50, s42, 1
    s_lshl_b32 s50, s50, 18
    s_and_b32 s51, s42, 1
    s_lshl_b32 s51, s51, 17
    s_add_u32 s50, s50, s51
    s_lshl_b32 s51, s48, 15
    s_add_u32 s50, s50, s51
    s_add_u32 s50, s50, s63
    s_add_u32 s96, s50, 3145728
    v_cmp_le_u32 s[6:7], 2, v3
    s_mov_b32 s98, 4294965248
    v_lshrrev_b32 v0, 5, v1
    v_and_b32 v125, 31, v1
    v_lshlrev_b32 v124, 12, v0
    v_lshl_add_u32 v124, v125, 4, v124
    s_andn2_b32 s50, s45, 8
    s_lshl_b32 s50, s50, 15
    s_lshl_b32 s51, s43, 13
    s_add_u32 s50, s50, s51
    s_lshl_b32 s51, s48, 9
    s_add_u32 s50, s50, s51
    s_add_u32 s54, s50, 1048576
    v_lshlrev_b32 v125, 1, v125
    v_lshl_add_u32 v125, v0, 9, v125
    s_lshl_b32 s50, s48, 6
    s_add_u32 s50, s50, 149504
    v_add_u32 v125, s50, v125
    v_lshlrev_b32 v126, 7, v0
    s_lshl_b32 s50, s43, 4
    s_add_u32 s50, s50, 148480
    v_add_u32 v126, s50, v126
    s_waitcnt lgkmcnt(0)
    v_readfirstlane_b32 s50, v120
    v_readfirstlane_b32 s51, v121
    s_nop 3
    s_and_b32 s56, s50, 2047
    s_bfe_u32 s57, s50, 720907
    s_lshr_b64 s[58:59], s[50:51], 22
    s_and_b32 s58, s58, 2047
    s_bfe_u32 s59, s51, 720897
    s_bitcmp0_b32 s44, 0
    s_cbranch_scc1 L_nodrain
    s_waitcnt vmcnt(0)
    v_mov_b32 v5, 8
    ds_write_b32 v7, v5 offset:0
    s_setprio 0
L_nodrain:
    s_mov_b32 s61, 0
Lsp_56:
    ds_read_b32 v120, v6 offset:32
    s_waitcnt lgkmcnt(0)
    v_readfirstlane_b32 s60, v120
    s_nop 3
    s_cmp_ge_u32 s60, 1
    s_cbranch_scc1 Lspd_57
    s_sleep 2
    s_add_u32 s61, s61, 1
    s_cmp_lt_u32 s61, 400000
    s_cbranch_scc1 Lsp_56
Lspd_57:
    ds_read_b128 v[8:11], v126 offset:0
    ds_read_b128 v[12:15], v126 offset:64
    ds_read_b128 v[16:19], v126 offset:256
    ds_read_b128 v[20:23], v126 offset:320
    s_mov_b32 s61, 0
Lsp_58:
    ds_read_b64 v[120:121], v6 offset:0
    s_waitcnt lgkmcnt(0)
    v_min_u32 v120, v120, v121
    s_nop 0
    v_readfirstlane_b32 s60, v120
    s_nop 3
    s_cmp_ge_u32 s60, 8
    s_cbranch_scc1 Lspd_59
    s_sleep 2
    s_add_u32 s61, s61, 1
    s_cmp_lt_u32 s61, 400000
    s_cbranch_scc1 Lsp_58
Lspd_59:
    s_mov_b32 s61, 0
L_m1l:
    s_and_b32 s55, s61, 31
    s_cmp_eq_u32 s55, 31
    s_cselect_b32 s55, 0, s3
    s_add_u32 s55, s55, s54
    s_add_u32 s50, s55, 0x40000
    buffer_load_dwordx4 v[128:131], v124, s[36:39], s55 offen sc1
    buffer_load_dwordx4 v[132:135], v124, s[36:39], s55 offen offset:2048 sc1
    buffer_load_dwordx4 v[136:139], v124, s[36:39], s50 offen sc1
    buffer_load_dwordx4 v[140:143], v124, s[36:39], s50 offen offset:2048 sc1
    s_waitcnt vmcnt(0)
    v_xor_b32 v128, s56, v128
    v_xor_b32 v129, s57, v129
    v_xor_b32 v130, s58, v130
    v_xor_b32 v131, s59, v131
    v_xor_b32 v132, s56, v132
    v_xor_b32 v133, s57, v133
    v_xor_b32 v134, s58, v134
    v_xor_b32 v135, s59, v135
    v_xor_b32 v136, s56, v136
    v_xor_b32 v137, s57, v137
    v_xor_b32 v138, s58, v138
    v_xor_b32 v139, s59, v139
    v_xor_b32 v140, s56, v140
    v_xor_b32 v141, s57, v141
    v_xor_b32 v142, s58, v142
    v_xor_b32 v143, s59, v143
    v_or3_b32 v5, v128, v129, v130
    v_or3_b32 v5, v5, v131, v132
    v_or3_b32 v5, v5, v133, v134
    v_or3_b32 v5, v5, v135, v136
    v_or3_b32 v5, v5, v137, v138
    v_or3_b32 v5, v5, v139, v140
    v_or3_b32 v5, v5, v141, v142
    v_or_b32 v5, v5, v143
    v_and_b32 v5, 2047, v5
    v_cmp_eq_u32 vcc, 0, v5
    s_nop 3
    s_cmp_eq_u64 vcc, -1
    s_cbranch_scc1 L_m1g
    s_add_u32 s61, s61, 1
    s_cmp_lt_u32 s61, 20000
    s_cbranch_scc1 L_m1l
L_m1g:
    v_pk_mul_f32 v[128:129], v[128:129], v[8:9]
    v_pk_mul_f32 v[130:131], v[130:131], v[10:11]
    v_pk_fma_f32 v[128:129], v[132:133], v[12:13], v[128:129]
    v_pk_fma_f32 v[130:131], v[134:135], v[14:15], v[130:131]
    v_pk_mul_f32 v[136:137], v[136:137], v[16:17]
    v_pk_mul_f32 v[138:139], v[138:139], v[18:19]
    v_pk_fma_f32 v[136:137], v[140:141], v[20:21], v[136:137]
    v_pk_fma_f32 v[138:139], v[142:143], v[22:23], v[138:139]
    v_mov_b32 v132, v128
    v_mov_b32 v133, v129
    v_mov_b32 v134, v130
    v_mov_b32 v135, v131
    v_mov_b32 v140, v136
    v_mov_b32 v141, v137
    v_mov_b32 v142, v138
    v_mov_b32 v143, v139
    v_permlane32_swap_b32 v128, v132
    v_permlane32_swap_b32 v129, v133
    v_permlane32_swap_b32 v130, v134
    v_permlane32_swap_b32 v131, v135
    v_permlane32_swap_b32 v136, v140
    v_permlane32_swap_b32 v137, v141
    v_permlane32_swap_b32 v138, v142
    v_permlane32_swap_b32 v139, v143
    s_nop 0
    v_pk_add_f32 v[128:129], v[128:129], v[132:133]
    v_pk_add_f32 v[130:131], v[130:131], v[134:135]
    v_cvt_pk_bf16_f32 v132, v128, v129
    v_cvt_pk_bf16_f32 v133, v130, v131
    s_nop 0
    v_cndmask_b32 v132, v132, v133, s[6:7]
    ds_write_b16 v125, v132 offset:0
    ds_write_b16_d16_hi v125, v132 offset:256
    v_pk_add_f32 v[136:137], v[136:137], v[140:141]
    v_pk_add_f32 v[138:139], v[138:139], v[142:143]
    v_cvt_pk_bf16_f32 v140, v136, v137
    v_cvt_pk_bf16_f32 v141, v138, v139
    s_nop 0
    v_cndmask_b32 v140, v140, v141, s[6:7]
    ds_write_b16 v125, v140 offset:1024
    ds_write_b16_d16_hi v125, v140 offset:1280
    s_waitcnt lgkmcnt(0)
    s_barrier
    ds_read_b128 v[144:147], v4 offset:0
    ds_read_b128 v[148:151], v4 offset:64
    ds_read_b128 v[152:155], v4 offset:128
    ds_read_b128 v[156:159], v4 offset:192
    s_waitcnt lgkmcnt(3)
    v_mfma_f32_16x16x32_bf16 v[104:107], v[144:147], v[40:43], 0
    v_mfma_f32_16x16x32_bf16 v[108:111], v[144:147], v[44:47], 0
    v_mfma_f32_16x16x32_bf16 v[112:115], v[144:147], v[48:51], 0
    v_mfma_f32_16x16x32_bf16 v[116:119], v[144:147], v[52:55], 0
    s_waitcnt lgkmcnt(2)
    v_mfma_f32_16x16x32_bf16 v[104:107], v[148:151], v[56:59], v[104:107]
    v_mfma_f32_16x16x32_bf16 v[108:111], v[148:151], v[60:63], v[108:111]
    v_mfma_f32_16x16x32_bf16 v[112:115], v[148:151], v[64:67], v[112:115]
    v_mfma_f32_16x16x32_bf16 v[116:119], v[148:151], v[68:71], v[116:119]
    s_waitcnt lgkmcnt(1)
    v_mfma_f32_16x16x32_bf16 v[104:107], v[152:155], v[72:75], v[104:107]
    v_mfma_f32_16x16x32_bf16 v[108:111], v[152:155], v[76:79], v[108:111]
    v_mfma_f32_16x16x32_bf16 v[112:115], v[152:155], v[80:83], v[112:115]
    v_mfma_f32_16x16x32_bf16 v[116:119], v[152:155], v[84:87], v[116:119]
    s_waitcnt lgkmcnt(0)
    v_mfma_f32_16x16x32_bf16 v[104:107], v[156:159], v[88:91], v[104:107]
    v_mfma_f32_16x16x32_bf16 v[108:111], v[156:159], v[92:95], v[108:111]
    v_mfma_f32_16x16x32_bf16 v[112:115], v[156:159], v[96:99], v[112:115]
    v_mfma_f32_16x16x32_bf16 v[116:119], v[156:159], v[100:103], v[116:119]
    s_nop 7
    v_cndmask_b32 v8, v104, v108, s[6:7]
    v_cndmask_b32 v9, v105, v109, s[6:7]
    v_cndmask_b32 v10, v106, v110, s[6:7]
    v_cndmask_b32 v11, v107, v111, s[6:7]
    v_and_b32 v8, s98, v8
    v_or_b32 v8, s56, v8
    v_and_b32 v9, s98, v9
    v_or_b32 v9, s57, v9
    v_and_b32 v10, s98, v10
    v_or_b32 v10, s58, v10
    v_and_b32 v11, s98, v11
    v_or_b32 v11, s59, v11
    buffer_store_dwordx4 v[8:11], v123, s[36:39], s96 offen offset:0 sc1
    v_cndmask_b32 v12, v112, v116, s[6:7]
    v_cndmask_b32 v13, v113, v117, s[6:7]
    v_cndmask_b32 v14, v114, v118, s[6:7]
    v_cndmask_b32 v15, v115, v119, s[6:7]
    v_and_b32 v12, s98, v12
    v_or_b32 v12, s56, v12
    v_and_b32 v13, s98, v13
    v_or_b32 v13, s57, v13
    v_and_b32 v14, s98, v14
    v_or_b32 v14, s58, v14
    v_and_b32 v15, s98, v15
    v_or_b32 v15, s59, v15
    buffer_store_dwordx4 v[12:15], v123, s[36:39], s96 offen offset:128 sc1
    s_waitcnt vmcnt(0)
    v_mov_b32 v6, 149056
    v_mov_b32 v7, 1
    s_mov_b64 exec, 1
    ds_add_u32 v6, v7 offset:56
    s_mov_b64 exec, -1
L_done:
    s_endpgm
.section .rodata,"a"
.p2align 6
.amdhsa_kernel standalone__gqa_block_cached__sampling_kernel
  .amdhsa_next_free_vgpr 168
  .amdhsa_next_free_sgpr 102
  .amdhsa_accum_offset 168
  .amdhsa_group_segment_fixed_size 0
  .amdhsa_kernarg_size 64
  .amdhsa_user_sgpr_count 2
  .amdhsa_user_sgpr_kernarg_segment_ptr 1
  .amdhsa_system_sgpr_workgroup_id_x 1
  .amdhsa_float_denorm_mode_32 3
.end_amdhsa_kernel
```
